```python
import torch

def _softmax(x, axis=-1):
    return torch.softmax(x, dim=axis)
def _gelu(x):
    return torch.nn.functional.gelu(x, approximate="tanh")
def _silu(x):
    return torch.nn.functional.silu(x)
def _sigmoid(x):
    return torch.sigmoid(x)
def _layernorm(x, axis=-1, eps=1e-5):
    m = x.mean(dim=axis, keepdim=True)
    v = x.var(dim=axis, keepdim=True, unbiased=False)
    return (x - m) / torch.sqrt(v + eps)
def _scatter_add(tgt, idx, src, axis=0):
    return tgt.clone().index_add_(axis, idx, src)
def _segment_sum(src, seg, n):
    out = torch.zeros((n,) + src.shape[1:], dtype=src.dtype)
    return out.index_add_(0, seg, src)
def _pad(x, pw):
    flat = tuple(v for pair in reversed(pw) for v in pair)
    return torch.nn.functional.pad(x, flat)

kernel_name = 'concat_heads__ssm_conv_s4__spectral_gfnet__prompt'

def setup_inputs():

    _w = (lambda a: (lambda t: t.to(torch.bfloat16) if t.is_floating_point() else t)(torch.as_tensor(a)))
    def _A_setup():
        B, L, D, N = 1, 2048, 576, 128
        A_re = -(lambda _x: torch.exp(torch.as_tensor(_x)))((lambda *s: torch.randn(*s, dtype=torch.bfloat16) * 3.2)(D, N))
        A_im = torch.pi * (lambda *s: torch.randn(*s, dtype=torch.bfloat16) * 0.05)(D, N)
        B_re = (lambda *s: torch.randn(*s, dtype=torch.bfloat16) * 0.1)(D, N)
        B_im = (lambda *s: torch.randn(*s, dtype=torch.bfloat16) * 0.1)(D, N)
        C_re = (lambda *s: torch.randn(*s, dtype=torch.bfloat16) * 0.1)(D, N)
        C_im = (lambda *s: torch.randn(*s, dtype=torch.bfloat16) * 0.1)(D, N)
        log_dt = (lambda *s: torch.randn(*s, dtype=torch.bfloat16) * 0.05)(D) * 0.5 - 4.0
        Dskip = (lambda *s: torch.randn(*s, dtype=torch.bfloat16) * 0.05)(D)
        return {
            "u": _w((lambda *s: torch.randn(*s, dtype=torch.bfloat16) * 0.05)(B, L, D)),
            "A_re": _w(A_re),
            "A_im": _w(A_im),
            "B_re": _w(B_re),
            "B_im": _w(B_im),
            "C_re": _w(C_re),
            "C_im": _w(C_im),
            "log_dt": _w(log_dt),
            "Dskip": _w(Dskip),
        }
    _A_in = _A_setup()

    def _B_setup():
        B, S, D = 1, 2048, 576
        Df = D // 2 + 1
        return {
            "x": _w((lambda *s: torch.randn(*s, dtype=torch.bfloat16) * 0.05)(B, S, D)),
            "w_r": _w((lambda *s: torch.randn(*s, dtype=torch.bfloat16) * 1.6)(S, Df) * 0.02),
            "w_i": _w((lambda *s: torch.randn(*s, dtype=torch.bfloat16) * 1.6)(S, Df) * 0.02),
        }
    _B_in = _B_setup()

    return {
        "A_u": _A_in["u"],
        "A_A_re": _A_in["A_re"],
        "A_A_im": _A_in["A_im"],
        "A_B_re": _A_in["B_re"],
        "A_B_im": _A_in["B_im"],
        "A_C_re": _A_in["C_re"],
        "A_C_im": _A_in["C_im"],
        "A_log_dt": _A_in["log_dt"],
        "A_Dskip": _A_in["Dskip"],
        "B_x": _B_in["x"],
        "B_w_r": _B_in["w_r"],
        "B_w_i": _B_in["w_i"],
    }

def reference(A_u, A_A_re, A_A_im, A_B_re, A_B_im, A_C_re, A_C_im, A_log_dt, A_Dskip, B_x, B_w_r, B_w_i):
    def _A_ref(u, A_re, A_im, B_re, B_im, C_re, C_im, log_dt, Dskip):
        Bsz, L, D = u.shape
        dt = torch.exp(log_dt)[:, None]
        A = A_re + 1j * A_im
        Bc = B_re + 1j * B_im
        Cc = C_re + 1j * C_im
        logdA = dt * A
        dB = dt * Bc
        l = (lambda x, dt: x.to(dt))(torch.arange(L), A_re.dtype)
        P = torch.exp(logdA[:, :, None] * l[None, None, :])
        K = torch.einsum("dn,dnl,dn->dl", Cc, P, dB).real
        L2 = 2 * L
        Kp = _pad(K, ((0, 0), (0, L)))
        up = (lambda x, *d: x.permute(*d))(u, 0, 2, 1)
        up = _pad(up, ((0, 0), (0, 0), (0, L)))
        Kf = (lambda x, axes=(-2,-1): torch.fft.rfft2(x.float(), dim=axes))(Kp[:, None, :], axes=(-2, -1))
        Uf = (lambda x, axes=(-2,-1): torch.fft.rfft2(x.float(), dim=axes))(up[:, :, None, :], axes=(-2, -1))
        Yf = Uf * Kf[None, :, :, :]
        y = (lambda x, s, axes=(-2,-1): torch.fft.irfft2(x, s=s, dim=axes).to(torch.bfloat16))(Yf, (1, L2), axes=(-2, -1))[:, :, 0, :L]
        y = (lambda x, *d: x.permute(*d))(y, 0, 2, 1) + u * Dskip[None, None, :]
        return y

    def _B_ref(x, w_r, w_i):
        B, S, D = x.shape
        X = (lambda x, axes=(-2,-1): torch.fft.rfft2(x.float(), dim=axes))(x, axes=(-2, -1))
        W = w_r + 1j * w_i
        X = X * W
        y = (lambda x, s, axes=(-2,-1): torch.fft.irfft2(x, s=s, dim=axes).to(torch.bfloat16))(X, (S, D), axes=(-2, -1))
        return y

    a = _A_ref(A_u, A_A_re, A_A_im, A_B_re, A_B_im, A_C_re, A_C_im, A_log_dt, A_Dskip)
    b = _B_ref(B_x, B_w_r, B_w_i)
    return torch.concatenate([a, b], axis=-1)
```

```asm
; @launch grid=(832,1,1) block=(256,1,1) lds=38144
.amdgcn_target "amdgcn-amd-amdhsa--gfx950"
.text
.globl concat_heads__ssm_conv_s4__spectral_gfnet__prompt_kernel
.p2align 8
.type concat_heads__ssm_conv_s4__spectral_gfnet__prompt_kernel,@function
concat_heads__ssm_conv_s4__spectral_gfnet__prompt_kernel:
    s_memrealtime s[12:13]
    s_load_dwordx16 s[16:31], s[0:1], 0
    s_load_dwordx8 s[32:39], s[0:1], 64
    s_load_dwordx4 s[40:43], s[0:1], 96
    s_load_dwordx2 s[44:45], s[0:1], 112
    v_lshrrev_b32 v1, 6, v0
    v_and_b32 v0, 63, v0
    v_readfirstlane_b32 s3, v1
    s_cmp_ge_u32 s2, 256
    s_cbranch_scc1 L_concat_heads__ssm_conv_s4__spectral_gfnet__prompt_kernel_r1
    s_cmp_ge_u32 s2, 8
    s_cbranch_scc1 L_nocpf
    s_getpc_b64 s[4:5]
L_pc:
    s_lshl_b32 s6, s3, 13
    v_lshl_add_u32 v2, v0, 7, s6
    v_min_u32 v2, L_code_end-L_pc-4, v2
    v_mov_b32 v3, s5
    v_add_co_u32 v2, vcc, s4, v2
    s_nop 1
    v_addc_co_u32 v3, vcc, 0, v3, vcc
    s_mov_b32 m0, 37120
    s_cmp_ge_u32 s3, 3
    s_cbranch_scc1 L_nocpf
    global_load_lds_dword v[2:3], off
L_nocpf:
    s_setprio 3
    s_mul_i32 s6, s3, 2304
    s_mul_i32 s7, s3, 2560
    s_mul_i32 s4, s3, 589824
    s_mul_i32 s5, s2, 1152
    s_add_u32 s4, s4, s5
    s_add_u32 s5, s4, 294912
    v_lshlrev_b32 v1, 4, v0
    s_mov_b32 m0, s6
    s_add_u32 s8, s6, 1152
    s_mov_b32 s50, 2359296
    s_mov_b32 s51, 0x20000
    s_waitcnt lgkmcnt(0)
    s_mov_b32 s48, s34
    s_mov_b32 s49, s35
    buffer_load_dwordx4 v1, s[48:51], s4 offen  lds
    s_mov_b64 exec, 0xff
    buffer_load_dwordx4 v1, s[48:51], s4 offen offset:1024  lds
    s_mov_b32 m0, s8
    s_nop 0
    buffer_load_dwordx4 v1, s[48:51], s5 offen offset:1024  lds
    s_mov_b64 exec, -1
    buffer_load_dwordx4 v1, s[48:51], s5 offen  lds
    s_lshr_b32 s9, s2, 3
    s_or_b32 s9, s9, s3
    s_cmp_lg_u32 s9, 0
    s_cbranch_scc1 L_b_notag
    s_or_b32 s12, s12, 1
    v_mov_b32 v6, 0
    v_mov_b32 v8, s12
    v_mov_b32 v9, 0
    s_mov_b64 exec, 1
    global_atomic_cmpswap v6, v[8:9], s[42:43] sc1
    s_mov_b64 exec, -1
L_b_notag:
    s_mov_b32 s52, s44
    s_mov_b32 s53, s45
    s_mov_b32 s54, 2641920
    s_mov_b32 s55, 0x20000
    s_add_u32 s56, s44, 4194304
    s_addc_u32 s57, s45, 0
    s_mov_b32 s58, 2654208
    s_mov_b32 s59, 0x20000
    s_mov_b32 s60, s36
    s_mov_b32 s61, s37
    s_mov_b32 s62, 1183744
    s_mov_b32 s63, 0x20000
    s_mov_b32 s64, s38
    s_mov_b32 s65, s39
    s_mov_b32 s66, 1183744
    s_mov_b32 s67, 0x20000
    v_and_b32 v2, 15, v0
    v_lshrrev_b32 v3, 4, v0
    v_cvt_f32_u32 v4, v2
    v_cvt_f32_u32 v5, v3
    v_mul_f32 v68, 0x3d638e39, v4
    v_mul_f32 v69, 0x41000000, v5
    v_mul_f32 v69, v69, v68
    v_mov_b32 v70, v69
    v_add_f32 v71, v69, v68
    v_fmamk_f32 v72, v68, 0x40000000, v69
    v_fmamk_f32 v73, v68, 0x40400000, v69
    v_fmamk_f32 v74, v68, 0x40800000, v69
    v_fmamk_f32 v75, v68, 0x40a00000, v69
    v_fmamk_f32 v76, v68, 0x40c00000, v69
    v_fmamk_f32 v77, v68, 0x40e00000, v69
    v_cos_f32 v78, v70
    v_cos_f32 v79, v71
    v_cos_f32 v80, v72
    v_cos_f32 v81, v73
    v_cos_f32 v82, v74
    v_cos_f32 v83, v75
    v_cos_f32 v84, v76
    v_cos_f32 v85, v77
    v_sin_f32 v86, v70
    v_sin_f32 v87, v71
    v_sin_f32 v88, v72
    v_sin_f32 v89, v73
    v_sin_f32 v90, v74
    v_sin_f32 v91, v75
    v_sin_f32 v92, v76
    v_sin_f32 v93, v77
    v_cvt_pk_bf16_f32 v8, v78, v79
    v_cvt_pk_bf16_f32 v12, -v86, -v87
    v_cvt_pk_bf16_f32 v9, v80, v81
    v_cvt_pk_bf16_f32 v13, -v88, -v89
    v_cvt_pk_bf16_f32 v10, v82, v83
    v_cvt_pk_bf16_f32 v14, -v90, -v91
    v_cvt_pk_bf16_f32 v11, v84, v85
    v_cvt_pk_bf16_f32 v15, -v92, -v93
    s_mov_b32 exec_lo, 0
    v_mov_b32 v9, 0
    v_mov_b32 v13, 0
    v_mov_b32 v10, 0
    v_mov_b32 v14, 0
    v_mov_b32 v11, 0
    v_mov_b32 v15, 0
    s_mov_b32 exec_hi, 0xffff0000
    v_mov_b32 v8, 0
    v_mov_b32 v12, 0
    s_mov_b64 exec, -1
    v_mul_f32 v68, 0x3ae38e39, v4
    v_mul_f32 v69, 4.0, v5
    v_mul_f32 v69, v69, v68
    v_mov_b32 v70, v69
    v_add_f32 v71, v69, v68
    v_fmamk_f32 v72, v68, 0x40000000, v69
    v_fmamk_f32 v73, v68, 0x40400000, v69
    v_fmamk_f32 v74, v68, 0x41800000, v69
    v_fmamk_f32 v75, v68, 0x41880000, v69
    v_fmamk_f32 v76, v68, 0x41900000, v69
    v_fmamk_f32 v77, v68, 0x41980000, v69
    v_cos_f32 v16, v70
    v_cos_f32 v17, v71
    v_cos_f32 v18, v72
    v_cos_f32 v19, v73
    v_cos_f32 v20, v74
    v_cos_f32 v21, v75
    v_cos_f32 v22, v76
    v_cos_f32 v23, v77
    v_sin_f32 v24, v70
    v_sin_f32 v25, v71
    v_sin_f32 v26, v72
    v_sin_f32 v27, v73
    v_sin_f32 v28, v74
    v_sin_f32 v29, v75
    v_sin_f32 v30, v76
    v_sin_f32 v31, v77
    v_mul_f32 v68, 0x3d000000, v4
    v_mul_f32 v69, 4.0, v5
    v_mul_f32 v69, v69, v68
    v_mov_b32 v70, v69
    v_add_f32 v71, v69, v68
    v_fmamk_f32 v72, v68, 0x40000000, v69
    v_fmamk_f32 v73, v68, 0x40400000, v69
    v_cos_f32 v74, v70
    v_cos_f32 v75, v71
    v_cos_f32 v76, v72
    v_cos_f32 v77, v73
    v_sin_f32 v78, v70
    v_sin_f32 v79, v71
    v_sin_f32 v80, v72
    v_sin_f32 v81, v73
    v_cvt_pk_bf16_f32 v32, v74, v78
    v_cvt_pk_bf16_f32 v48, -v78, v74
    v_cvt_pk_bf16_f32 v33, v75, v79
    v_cvt_pk_bf16_f32 v49, -v79, v75
    v_cvt_pk_bf16_f32 v34, v76, v80
    v_cvt_pk_bf16_f32 v50, -v80, v76
    v_cvt_pk_bf16_f32 v35, v77, v81
    v_cvt_pk_bf16_f32 v51, -v81, v77
    v_and_b32 v68, 1, v0
    v_mul_u32_u24 v68, 0x8000, v68
    v_lshl_or_b32 v68, v68, 16, v68
    v_mov_b32 v36, v32
    v_xor_b32 v37, 0x80008000, v33
    v_mov_b32 v38, v34
    v_xor_b32 v39, 0x80008000, v35
    v_xor_b32 v40, v68, v32
    v_xor_b32 v41, v68, v33
    v_xor_b32 v42, v68, v34
    v_xor_b32 v43, v68, v35
    v_xor_b32 v44, v68, v36
    v_xor_b32 v45, v68, v37
    v_xor_b32 v46, v68, v38
    v_xor_b32 v47, v68, v39
    v_xor_b32 v52, 0x80008000, v48
    v_mov_b32 v53, v49
    v_xor_b32 v54, 0x80008000, v50
    v_mov_b32 v55, v51
    v_xor_b32 v56, v68, v48
    v_xor_b32 v57, v68, v49
    v_xor_b32 v58, v68, v50
    v_xor_b32 v59, v68, v51
    v_xor_b32 v60, v68, v52
    v_xor_b32 v61, v68, v53
    v_xor_b32 v62, v68, v54
    v_xor_b32 v63, v68, v55
    v_bfe_u32 v68, v0, 1, 4
    v_cvt_f32_u32 v68, v68
    v_lshrrev_b32 v69, 5, v0
    v_cvt_f32_u32 v69, v69
    v_and_b32 v70, 1, v0
    v_cvt_f32_u32 v70, v70
    v_mul_f32 v70, 0x3e800000, v70
    v_cvt_f32_u32 v71, s2
    v_mul_f32 v71, 0x3a000000, v71
    v_fmac_f32 v71, 0.5, v69
    v_fma_f32 v70, v68, v71, v70
    v_mul_f32 v71, 0x3e000000, v68
    v_mov_b32 v72, v70
    v_add_f32 v73, v70, v71
    v_fmamk_f32 v74, v71, 0x40000000, v70
    v_fmamk_f32 v75, v71, 0x40400000, v70
    v_cos_f32 v76, v72
    v_cos_f32 v77, v73
    v_cos_f32 v78, v74
    v_cos_f32 v79, v75
    v_sin_f32 v80, v72
    v_sin_f32 v81, v73
    v_sin_f32 v82, v74
    v_sin_f32 v83, v75
    v_cvt_pk_bf16_f32 v64, v76, v80
    v_cvt_pk_bf16_f32 v65, v77, v81
    v_cvt_pk_bf16_f32 v66, v78, v82
    v_cvt_pk_bf16_f32 v67, v79, v83
    v_bfe_u32 v68, v0, 2, 2
    v_lshl_add_u32 v68, v3, 3, v68
    v_add_u32 v69, 4, v68
    v_min_u32 v68, 17, v68
    v_min_u32 v69, 17, v69
    v_and_b32 v70, 3, v0
    v_lshlrev_b32 v70, 3, v70
    v_add_u32 v70, s6, v70
    v_lshl_add_u32 v6, v68, 6, v70
    v_lshl_add_u32 v7, v69, 6, v70
    s_add_u32 s7, s7, 9216
    v_mul_u32_u24 v124, 18, v2
    v_lshl_add_u32 v124, v3, 2, v124
    v_sub_u32 v125, 285, v124
    v_lshl_add_u32 v124, v124, 2, s7
    v_lshl_add_u32 v125, v125, 2, s7
    v_and_b32 v116, 31, v0
    v_lshrrev_b32 v117, 5, v0
    v_cmp_lt_u32 vcc, 15, v116
    s_nop 1
    v_subbrev_co_u32 v118, vcc, 0, v116, vcc
    v_mul_u32_u24 v126, 5120, v117
    v_lshl_add_u32 v126, v118, 2, v126
    s_mul_i32 s8, s3, 120
    s_add_u32 s8, s8, 9216
    v_add_u32 v126, s8, v126
    v_add_u32 v5, 480, v126
    v_mul_u32_u24 v1, 40, v117
    v_bfe_u32 v4, v0, 4, 1
    v_add_u32 v1, v1, v4
    v_mul_u32_u24 v1, 16512, v1
    v_lshl_add_u32 v1, v2, 2, v1
    s_and_b32 s4, s2, 15
    s_lshl_b32 s4, s4, 10
    s_bfe_u32 s5, s2, 0x20004
    s_lshl_b32 s5, s5, 8
    s_add_u32 s4, s4, s5
    s_lshr_b32 s5, s2, 6
    s_lshl_b32 s5, s5, 6
    s_add_u32 s4, s4, s5
    s_mul_i32 s5, s3, 33024
    s_add_u32 s8, s4, s5
    v_bfe_u32 v123, v0, 4, 2
    v_mul_u32_u24 v123, 4624, v123
    v_min_u32 v122, 9, v2
    v_lshl_add_u32 v123, v122, 6, v123
    s_lshr_b32 s12, s2, 3
    s_lshl_b32 s12, s12, 1
    s_and_b32 s13, s3, 1
    s_add_u32 s12, s12, s13
    s_lshl_b32 s70, s12, 5
    s_and_b32 s13, s2, 7
    s_add_u32 s70, s70, s13
    s_mul_i32 s70, s70, 578
    s_and_b32 s70, s70, -4
    s_cmp_ge_u32 s3, 2
    s_cselect_b32 s72, s38, s36
    s_cselect_b32 s73, s39, s37
    s_mov_b32 s74, 1183744
    s_mov_b32 s75, 0x20000
    s_lshl_b32 s13, s3, 8
    s_add_u32 m0, s13, 36096
    s_setprio 3
    s_waitcnt vmcnt(0)
    ds_read_b64_tr_b16 v[68:69], v6 offset:0
    ds_read_b64_tr_b16 v[70:71], v7 offset:0
    ds_read_b64_tr_b16 v[72:73], v6 offset:32
    ds_read_b64_tr_b16 v[74:75], v7 offset:32
    ds_read_b64_tr_b16 v[76:77], v6 offset:1152
    ds_read_b64_tr_b16 v[78:79], v7 offset:1152
    ds_read_b64_tr_b16 v[80:81], v6 offset:1184
    ds_read_b64_tr_b16 v[82:83], v7 offset:1184
    v_add_u32 v6, 960, v126
    buffer_load_dword v123, s[72:75], s70 offen lds
    s_waitcnt lgkmcnt(6)
    v_mfma_f32_16x16x32_bf16 v[84:87], v[68:71], v[8:11], 0
    v_mfma_f32_16x16x32_bf16 v[88:91], v[68:71], v[12:15], 0
    s_waitcnt lgkmcnt(4)
    v_mfma_f32_16x16x32_bf16 v[92:95], v[72:75], v[8:11], 0
    v_mfma_f32_16x16x32_bf16 v[96:99], v[72:75], v[12:15], 0
    s_waitcnt lgkmcnt(2)
    v_mfma_f32_16x16x32_bf16 v[100:103], v[76:79], v[8:11], 0
    v_mfma_f32_16x16x32_bf16 v[104:107], v[76:79], v[12:15], 0
    s_waitcnt lgkmcnt(0)
    v_mfma_f32_16x16x32_bf16 v[108:111], v[80:83], v[8:11], 0
    v_mfma_f32_16x16x32_bf16 v[112:115], v[80:83], v[12:15], 0
    s_load_dword s15, s[42:43], 0
    v_pk_mul_f32 v[116:117], v[84:85], v[16:17]
    v_pk_mul_f32 v[120:121], v[88:89], v[16:17]
    v_pk_mul_f32 v[118:119], v[86:87], v[18:19]
    v_pk_mul_f32 v[122:123], v[90:91], v[18:19]
    v_pk_fma_f32 v[116:117], v[88:89], v[24:25], v[116:117]
    v_pk_fma_f32 v[120:121], v[84:85], v[24:25], v[120:121] neg_lo:[0,1,0] neg_hi:[0,1,0]
    v_pk_fma_f32 v[118:119], v[90:91], v[26:27], v[118:119]
    v_pk_fma_f32 v[122:123], v[86:87], v[26:27], v[122:123] neg_lo:[0,1,0] neg_hi:[0,1,0]
    v_cvt_pk_bf16_f32 v68, v116, v120
    v_cvt_pk_bf16_f32 v69, v117, v121
    v_cvt_pk_bf16_f32 v70, v118, v122
    v_cvt_pk_bf16_f32 v71, v119, v123
    v_pk_mul_f32 v[116:117], v[92:93], v[20:21]
    v_pk_mul_f32 v[120:121], v[96:97], v[20:21]
    v_pk_mul_f32 v[118:119], v[94:95], v[22:23]
    v_pk_mul_f32 v[122:123], v[98:99], v[22:23]
    v_pk_fma_f32 v[116:117], v[96:97], v[28:29], v[116:117]
    v_pk_fma_f32 v[120:121], v[92:93], v[28:29], v[120:121] neg_lo:[0,1,0] neg_hi:[0,1,0]
    v_pk_fma_f32 v[118:119], v[98:99], v[30:31], v[118:119]
    v_pk_fma_f32 v[122:123], v[94:95], v[30:31], v[122:123] neg_lo:[0,1,0] neg_hi:[0,1,0]
    v_cvt_pk_bf16_f32 v72, v116, v120
    v_cvt_pk_bf16_f32 v73, v117, v121
    v_cvt_pk_bf16_f32 v74, v118, v122
    v_cvt_pk_bf16_f32 v75, v119, v123
    v_mfma_f32_16x16x32_bf16 v[84:87], v[68:71], v[32:35], 0
    s_nop 0
    s_nop 0
    v_mfma_f32_16x16x32_bf16 v[84:87], v[72:75], v[40:43], v[84:87]
    v_mfma_f32_16x16x32_bf16 v[88:91], v[68:71], v[48:51], 0
    v_mfma_f32_16x16x32_bf16 v[88:91], v[72:75], v[56:59], v[88:91]
    v_mfma_f32_16x16x32_bf16 v[92:95], v[68:71], v[36:39], 0
    v_mfma_f32_16x16x32_bf16 v[92:95], v[72:75], v[44:47], v[92:95]
    v_mfma_f32_16x16x32_bf16 v[96:99], v[68:71], v[52:55], 0
    v_mfma_f32_16x16x32_bf16 v[96:99], v[72:75], v[60:63], v[96:99]
    v_pk_mul_f32 v[116:117], v[100:101], v[16:17]
    v_pk_mul_f32 v[120:121], v[104:105], v[16:17]
    v_pk_mul_f32 v[118:119], v[102:103], v[18:19]
    v_pk_mul_f32 v[122:123], v[106:107], v[18:19]
    v_pk_fma_f32 v[116:117], v[104:105], v[24:25], v[116:117]
    v_pk_fma_f32 v[120:121], v[100:101], v[24:25], v[120:121] neg_lo:[0,1,0] neg_hi:[0,1,0]
    v_pk_fma_f32 v[118:119], v[106:107], v[26:27], v[118:119]
    v_pk_fma_f32 v[122:123], v[102:103], v[26:27], v[122:123] neg_lo:[0,1,0] neg_hi:[0,1,0]
    v_cvt_pk_bf16_f32 v76, v116, v120
    v_cvt_pk_bf16_f32 v77, v117, v121
    v_cvt_pk_bf16_f32 v78, v118, v122
    v_cvt_pk_bf16_f32 v79, v119, v123
    v_pk_mul_f32 v[116:117], v[108:109], v[20:21]
    v_pk_mul_f32 v[120:121], v[112:113], v[20:21]
    v_pk_mul_f32 v[118:119], v[110:111], v[22:23]
    v_pk_mul_f32 v[122:123], v[114:115], v[22:23]
    v_pk_fma_f32 v[116:117], v[112:113], v[28:29], v[116:117]
    v_pk_fma_f32 v[120:121], v[108:109], v[28:29], v[120:121] neg_lo:[0,1,0] neg_hi:[0,1,0]
    v_pk_fma_f32 v[118:119], v[114:115], v[30:31], v[118:119]
    v_pk_fma_f32 v[122:123], v[110:111], v[30:31], v[122:123] neg_lo:[0,1,0] neg_hi:[0,1,0]
    v_cvt_pk_bf16_f32 v80, v116, v120
    v_cvt_pk_bf16_f32 v81, v117, v121
    v_cvt_pk_bf16_f32 v82, v118, v122
    v_cvt_pk_bf16_f32 v83, v119, v123
    v_mfma_f32_16x16x32_bf16 v[100:103], v[76:79], v[32:35], 0
    s_nop 0
    s_nop 0
    v_mfma_f32_16x16x32_bf16 v[100:103], v[80:83], v[40:43], v[100:103]
    v_mfma_f32_16x16x32_bf16 v[104:107], v[76:79], v[48:51], 0
    v_mfma_f32_16x16x32_bf16 v[104:107], v[80:83], v[56:59], v[104:107]
    v_mfma_f32_16x16x32_bf16 v[108:111], v[76:79], v[36:39], 0
    v_mfma_f32_16x16x32_bf16 v[108:111], v[80:83], v[44:47], v[108:111]
    v_mfma_f32_16x16x32_bf16 v[112:115], v[76:79], v[52:55], 0
    v_mfma_f32_16x16x32_bf16 v[112:115], v[80:83], v[60:63], v[112:115]
    v_cvt_pk_bf16_f32 v68, v84, v88
    v_cvt_pk_bf16_f32 v69, v85, v89
    v_cvt_pk_bf16_f32 v70, v86, v90
    v_cvt_pk_bf16_f32 v71, v87, v91
    v_cvt_pk_bf16_f32 v72, v92, v96
    v_cvt_pk_bf16_f32 v73, v93, v97
    v_cvt_pk_bf16_f32 v74, v94, v98
    v_cvt_pk_bf16_f32 v75, v95, v99
    ds_write2_b32 v124, v68, v69 offset0:0 offset1:1
    ds_write2_b32 v124, v70, v71 offset0:2 offset1:3
    ds_write2_b32 v125, v72, v73 offset0:3 offset1:2
    ds_write2_b32 v125, v74, v75 offset0:1 offset1:0
    v_add_u32 v124, 1280, v124
    v_add_u32 v125, 1280, v125
    v_cvt_pk_bf16_f32 v76, v100, v104
    v_cvt_pk_bf16_f32 v77, v101, v105
    v_cvt_pk_bf16_f32 v78, v102, v106
    v_cvt_pk_bf16_f32 v79, v103, v107
    v_cvt_pk_bf16_f32 v80, v108, v112
    v_cvt_pk_bf16_f32 v81, v109, v113
    v_cvt_pk_bf16_f32 v82, v110, v114
    v_cvt_pk_bf16_f32 v83, v111, v115
    ds_write2_b32 v124, v76, v77 offset0:0 offset1:1
    ds_write2_b32 v124, v78, v79 offset0:2 offset1:3
    ds_write2_b32 v125, v80, v81 offset0:3 offset1:2
    ds_write2_b32 v125, v82, v83 offset0:1 offset1:0
    s_waitcnt lgkmcnt(0)
    s_barrier
    ds_read2st64_b32 v[68:69], v126 offset0:0 offset1:5
    ds_read2st64_b32 v[70:71], v126 offset0:10 offset1:15
    ds_read2st64_b32 v[72:73], v5 offset0:0 offset1:5
    ds_read2st64_b32 v[74:75], v5 offset0:10 offset1:15
    ds_read2st64_b32 v[76:77], v6 offset0:0 offset1:5
    ds_read2st64_b32 v[78:79], v6 offset0:10 offset1:15
    s_cmp_lg_u32 s15, 0
    s_cbranch_scc1 L_tok1
    s_mov_b32 s14, 200000
    v_mov_b32 v116, 0
L_tag1:
    global_load_dword v117, v116, s[42:43] sc1
    s_sub_u32 s14, s14, 1
    s_waitcnt vmcnt(0)
    v_readfirstlane_b32 s15, v117
    s_nop 1
    s_cmp_lg_u32 s15, 0
    s_cbranch_scc1 L_tok1
    s_cmp_lg_u32 s14, 0
    s_cbranch_scc1 L_tag1
L_tok1:
    v_mov_b32 v48, s15
    v_mov_b32 v49, s15
    v_mov_b32 v50, s15
    v_mov_b32 v51, s15
    v_mov_b32 v52, s15
    v_mov_b32 v53, s15
    v_mov_b32 v54, s15
    v_mov_b32 v55, s15
    v_mov_b32 v56, s15
    v_mov_b32 v57, s15
    v_mov_b32 v58, s15
    v_mov_b32 v59, s15
    s_waitcnt lgkmcnt(4)
    v_mfma_f32_32x32x16_bf16 v[84:99], v[64:67], v[68:71], 0
    s_waitcnt lgkmcnt(2)
    v_mfma_f32_32x32x16_bf16 v[100:115], v[64:67], v[72:75], 0
    s_waitcnt lgkmcnt(0)
    v_mfma_f32_32x32x16_bf16 v[32:47], v[64:67], v[76:79], 0
    s_mov_b32 exec_lo, 0x7fff7fff
    s_mov_b32 exec_hi, 0x7fff7fff
    s_nop 5
    v_cvt_pk_bf16_f32 v48, v84, v85
    v_cvt_pk_bf16_f32 v49, v86, v87
    v_cvt_pk_bf16_f32 v50, v88, v89
    v_cvt_pk_bf16_f32 v51, v90, v91
    s_mov_b64 exec, -1
    s_add_u32 s9, s8, 0
    s_nop 0
    buffer_store_dword v48, v1, s[52:55], s9 offen sc1
    s_add_u32 s9, s8, 330240
    buffer_store_dword v49, v1, s[52:55], s9 offen sc1
    s_add_u32 s9, s8, 1320960
    buffer_store_dword v50, v1, s[52:55], s9 offen sc1
    s_add_u32 s9, s8, 1651200
    buffer_store_dword v51, v1, s[52:55], s9 offen sc1
    s_mov_b32 exec_lo, 0x7fff7fff
    s_mov_b32 exec_hi, 0x7fff7fff
    v_cvt_pk_bf16_f32 v52, v100, v101
    v_cvt_pk_bf16_f32 v53, v102, v103
    v_cvt_pk_bf16_f32 v54, v104, v105
    v_cvt_pk_bf16_f32 v55, v106, v107
    s_mov_b64 exec, -1
    s_nop 0
    s_add_u32 s9, s8, 132096
    buffer_store_dword v52, v1, s[52:55], s9 offen sc1
    s_add_u32 s9, s8, 462336
    buffer_store_dword v53, v1, s[52:55], s9 offen sc1
    s_add_u32 s9, s8, 1453056
    buffer_store_dword v54, v1, s[52:55], s9 offen sc1
    s_add_u32 s9, s8, 1783296
    buffer_store_dword v55, v1, s[52:55], s9 offen sc1
    s_cmp_ge_u32 s3, 2
    s_cbranch_scc1 L_b1_end
    s_mov_b32 exec_lo, 0x7fff7fff
    s_mov_b32 exec_hi, 0x7fff7fff
    v_cvt_pk_bf16_f32 v56, v32, v33
    v_cvt_pk_bf16_f32 v57, v34, v35
    v_cvt_pk_bf16_f32 v58, v36, v37
    v_cvt_pk_bf16_f32 v59, v38, v39
    s_mov_b64 exec, -1
    s_nop 0
    s_add_u32 s9, s8, 264192
    buffer_store_dword v56, v1, s[52:55], s9 offen sc1
    s_add_u32 s9, s8, 594432
    buffer_store_dword v57, v1, s[52:55], s9 offen sc1
    s_add_u32 s9, s8, 1585152
    buffer_store_dword v58, v1, s[52:55], s9 offen sc1
    s_add_u32 s9, s8, 1915392
    buffer_store_dword v59, v1, s[52:55], s9 offen sc1
L_b1_end:
    v_and_b32 v2, 15, v0
    v_lshrrev_b32 v3, 4, v0
    v_cvt_f32_u32 v4, v2
    v_cvt_f32_u32 v5, v3
    s_barrier
    s_cmp_lt_u32 s2, 96
    s_cbranch_scc1 L_b3
L_b2:
    s_setprio 3
    s_and_b32 s4, s2, 7
    s_lshr_b32 s5, s2, 3
    s_sub_u32 s5, s5, 12
    s_add_u32 s46, s4, s5
    s_mul_i32 s72, s4, 20
    s_add_u32 s72, s72, s5
    s_mul_i32 s72, s72, 16512
    s_lshl_b32 s7, s3, 12
    s_add_u32 s72, s72, s7
    s_mul_i32 s6, s4, 1280
    s_lshl_b32 s7, s5, 6
    s_add_u32 s6, s6, s7
    s_mul_i32 s7, s3, 41472
    s_add_u32 s8, s6, s7
    v_mul_f32 v80, 4.0, v5
    v_mul_f32 v81, 0x3d800000, v4
    v_mul_f32 v82, v80, v81
    v_mul_f32 v83, 0x3b800000, v4
    s_lshl_b32 s6, s3, 2
    v_cvt_f32_u32 v84, s6
    v_mov_b32 v88, v82
    v_add_f32 v89, v82, v81
    v_fmamk_f32 v90, v81, 0x40000000, v82
    v_fmamk_f32 v91, v81, 0x40400000, v82
    v_cos_f32 v92, v88
    v_cos_f32 v93, v89
    v_cos_f32 v94, v90
    v_cos_f32 v95, v91
    v_sin_f32 v96, v88
    v_sin_f32 v97, v89
    v_sin_f32 v98, v90
    v_sin_f32 v99, v91
    v_cvt_pk_bf16_f32 v8, v92, v96
    v_cvt_pk_bf16_f32 v12, -v96, v92
    v_cvt_pk_bf16_f32 v9, v93, v97
    v_cvt_pk_bf16_f32 v13, -v97, v93
    v_cvt_pk_bf16_f32 v10, v94, v98
    v_cvt_pk_bf16_f32 v14, -v98, v94
    v_cvt_pk_bf16_f32 v11, v95, v99
    v_cvt_pk_bf16_f32 v15, -v99, v95
    v_mul_f32 v84, v84, v83
    v_add_f32 v88, v88, v84
    v_add_f32 v89, v89, v84
    v_add_f32 v90, v90, v84
    v_add_f32 v91, v91, v84
    v_cos_f32 v92, v88
    v_cos_f32 v93, v89
    v_cos_f32 v94, v90
    v_cos_f32 v95, v91
    v_sin_f32 v96, v88
    v_sin_f32 v97, v89
    v_sin_f32 v98, v90
    v_sin_f32_e64 v99, v91
    v_cvt_pk_bf16_f32 v16, v92, v96
    v_cvt_pk_bf16_f32 v20, -v96, v92
    v_cvt_pk_bf16_f32 v17, v93, v97
    v_cvt_pk_bf16_f32 v21, -v97, v93
    v_cvt_pk_bf16_f32 v18, v94, v98
    v_cvt_pk_bf16_f32 v22, -v98, v94
    v_cvt_pk_bf16_f32 v19, v95, v99
    v_cvt_pk_bf16_f32 v23, -v99, v95
    v_add_f32 v88, v88, v83
    v_add_f32 v89, v89, v83
    v_add_f32 v90, v90, v83
    v_add_f32 v91, v91, v83
    v_cos_f32 v92, v88
    v_cos_f32 v93, v89
    v_cos_f32 v94, v90
    v_cos_f32 v95, v91
    v_sin_f32 v96, v88
    v_sin_f32 v97, v89
    v_sin_f32 v98, v90
    v_sin_f32 v99, v91
    v_cvt_pk_bf16_f32 v24, v92, v96
    v_cvt_pk_bf16_f32 v28, -v96, v92
    v_cvt_pk_bf16_f32 v25, v93, v97
    v_cvt_pk_bf16_f32 v29, -v97, v93
    v_cvt_pk_bf16_f32 v26, v94, v98
    v_cvt_pk_bf16_f32 v30, -v98, v94
    v_cvt_pk_bf16_f32 v27, v95, v99
    v_cvt_pk_bf16_f32 v31, -v99, v95
    v_add_f32 v88, v88, v83
    v_add_f32 v89, v89, v83
    v_add_f32 v90, v90, v83
    v_add_f32 v91, v91, v83
    v_cos_f32 v92, v88
    v_cos_f32 v93, v89
    v_cos_f32 v94, v90
    v_cos_f32 v95, v91
    v_sin_f32 v96, v88
    v_sin_f32 v97, v89
    v_sin_f32 v98, v90
    v_sin_f32 v99, v91
    v_cvt_pk_bf16_f32 v32, v92, v96
    v_cvt_pk_bf16_f32 v36, -v96, v92
    v_cvt_pk_bf16_f32 v33, v93, v97
    v_cvt_pk_bf16_f32 v37, -v97, v93
    v_cvt_pk_bf16_f32 v34, v94, v98
    v_cvt_pk_bf16_f32 v38, -v98, v94
    v_cvt_pk_bf16_f32 v35, v95, v99
    v_cvt_pk_bf16_f32 v39, -v99, v95
    v_add_f32 v88, v88, v83
    v_add_f32 v89, v89, v83
    v_add_f32 v90, v90, v83
    v_add_f32 v91, v91, v83
    v_cos_f32 v92, v88
    v_cos_f32 v93, v89
    v_cos_f32 v94, v90
    v_cos_f32 v95, v91
    v_sin_f32 v96, v88
    v_sin_f32 v97, v89
    v_sin_f32 v98, v90
    v_sin_f32 v99, v91
    v_cvt_pk_bf16_f32 v40, v92, v96
    v_cvt_pk_bf16_f32 v44, -v96, v92
    v_cvt_pk_bf16_f32 v41, v93, v97
    v_cvt_pk_bf16_f32 v45, -v97, v93
    v_cvt_pk_bf16_f32 v42, v94, v98
    v_cvt_pk_bf16_f32 v46, -v98, v94
    v_cvt_pk_bf16_f32 v43, v95, v99
    v_cvt_pk_bf16_f32 v47, -v99, v95
    v_lshlrev_b32 v4, 2, v0
    v_lshlrev_b32 v80, 2, v2
    v_mul_u32_u24 v1, 663552, v3
    v_add_u32 v1, v1, v80
    v_mul_u32_u24 v6, 320, v3
    v_add_u32 v6, v6, v80
    s_mul_i32 s6, s3, 5120
    s_and_b32 s7, s3, 1
    s_lshl_b32 s7, s7, 6
    s_add_u32 s6, s6, s7
    s_add_u32 s6, s6, 5120
    v_add_u32 v7, s6, v6
    s_and_b32 s7, s46, 1
    v_add_u32 v81, s7, v2
    v_lshlrev_b32 v81, 1, v81
    v_lshl_add_u32 v81, v3, 11, v81
    v_mul_u32_u24 v2, 5120, v3
    v_and_b32 v82, 16, v0
    v_lshl_add_u32 v2, v82, 2, v2
    s_mul_i32 s6, s3, 320
    s_add_u32 s6, s6, 5120
    v_add3_u32 v2, v2, v80, s6
    s_lshl_b32 s6, s3, 7
    v_add_u32 v3, s6, v81
    s_waitcnt vmcnt(0)
    s_setprio 3
    s_and_b32 s70, s2, 7
    s_lshr_b32 s71, s2, 3
    s_sub_u32 s71, s71, 12
    v_lshrrev_b32 v80, 1, v0
    v_mul_u32_u24 v80, 4624, v80
    v_and_b32 v81, 1, v0
    v_lshl_add_u32 v80, v81, 4, v80
    s_mul_i32 s74, s70, 578
    s_mul_i32 s75, s71, 30
    s_add_u32 s74, s74, s75
    s_mul_i32 s75, s3, 295936
    s_add_u32 s74, s74, s75
    s_and_b32 s74, s74, -4
    s_add_u32 s75, s74, 147968
    s_lshl_b32 s71, s3, 11
    s_add_u32 m0, s71, 19456
    s_nop 0
    buffer_load_dwordx4 v80, s[60:63], s74 offen  lds
    s_add_u32 m0, s71, 20480
    s_nop 0
    buffer_load_dwordx4 v80, s[60:63], s75 offen  lds
    s_add_u32 m0, s71, 27648
    s_nop 0
    buffer_load_dwordx4 v80, s[64:67], s74 offen  lds
    s_add_u32 m0, s71, 28672
    s_nop 0
    buffer_load_dwordx4 v80, s[64:67], s75 offen  lds
    s_waitcnt vmcnt(0)
    s_barrier
    ds_read_u16_d16_hi v48, v3 offset:19456
    ds_read_u16_d16_hi v52, v3 offset:27648
    ds_read_u16_d16_hi v49, v3 offset:19968
    ds_read_u16_d16_hi v53, v3 offset:28160
    ds_read_u16_d16_hi v50, v3 offset:20480
    ds_read_u16_d16_hi v54, v3 offset:28672
    ds_read_u16_d16_hi v51, v3 offset:20992
    ds_read_u16_d16_hi v55, v3 offset:29184
    s_waitcnt lgkmcnt(6)
    s_nop 0
    ds_read_u16_d16_hi v56, v3 offset:19488
    ds_read_u16_d16_hi v60, v3 offset:27680
    ds_read_u16_d16_hi v57, v3 offset:20000
    ds_read_u16_d16_hi v61, v3 offset:28192
    ds_read_u16_d16_hi v58, v3 offset:20512
    ds_read_u16_d16_hi v62, v3 offset:28704
    ds_read_u16_d16_hi v59, v3 offset:21024
    ds_read_u16_d16_hi v63, v3 offset:29216
    s_waitcnt lgkmcnt(6)
    s_nop 0
    ds_read_u16_d16_hi v64, v3 offset:19520
    ds_read_u16_d16_hi v68, v3 offset:27712
    ds_read_u16_d16_hi v65, v3 offset:20032
    ds_read_u16_d16_hi v69, v3 offset:28224
    ds_read_u16_d16_hi v66, v3 offset:20544
    ds_read_u16_d16_hi v70, v3 offset:28736
    ds_read_u16_d16_hi v67, v3 offset:21056
    ds_read_u16_d16_hi v71, v3 offset:29248
    s_waitcnt lgkmcnt(6)
    s_nop 0
    ds_read_u16_d16_hi v72, v3 offset:19552
    ds_read_u16_d16_hi v76, v3 offset:27744
    ds_read_u16_d16_hi v73, v3 offset:20064
    ds_read_u16_d16_hi v77, v3 offset:28256
    ds_read_u16_d16_hi v74, v3 offset:20576
    ds_read_u16_d16_hi v78, v3 offset:28768
    ds_read_u16_d16_hi v75, v3 offset:21088
    ds_read_u16_d16_hi v79, v3 offset:29280
    s_waitcnt lgkmcnt(0)
    s_barrier
    buffer_load_dword v80, v4, s[52:55], s72 offen offset:0 sc1
    buffer_load_dword v81, v4, s[52:55], s72 offen offset:256 sc1
    buffer_load_dword v82, v4, s[52:55], s72 offen offset:512 sc1
    buffer_load_dword v83, v4, s[52:55], s72 offen offset:768 sc1
    buffer_load_dword v84, v4, s[52:55], s72 offen offset:1024 sc1
    buffer_load_dword v85, v4, s[52:55], s72 offen offset:1280 sc1
    buffer_load_dword v86, v4, s[52:55], s72 offen offset:1536 sc1
    buffer_load_dword v87, v4, s[52:55], s72 offen offset:1792 sc1
    buffer_load_dword v88, v4, s[52:55], s72 offen offset:2048 sc1
    buffer_load_dword v89, v4, s[52:55], s72 offen offset:2304 sc1
    buffer_load_dword v90, v4, s[52:55], s72 offen offset:2560 sc1
    buffer_load_dword v91, v4, s[52:55], s72 offen offset:2816 sc1
    buffer_load_dword v92, v4, s[52:55], s72 offen offset:3072 sc1
    buffer_load_dword v93, v4, s[52:55], s72 offen offset:3328 sc1
    buffer_load_dword v94, v4, s[52:55], s72 offen offset:3584 sc1
    buffer_load_dword v95, v4, s[52:55], s72 offen offset:3840 sc1
    s_waitcnt vmcnt(0)
    v_xor_b32 v96, s15, v80
    v_bitop3_b32 v96, v81, v96, s15 bitop3:0xde
    v_bitop3_b32 v96, v82, v96, s15 bitop3:0xde
    v_bitop3_b32 v96, v83, v96, s15 bitop3:0xde
    v_bitop3_b32 v96, v84, v96, s15 bitop3:0xde
    v_bitop3_b32 v96, v85, v96, s15 bitop3:0xde
    v_bitop3_b32 v96, v86, v96, s15 bitop3:0xde
    v_bitop3_b32 v96, v87, v96, s15 bitop3:0xde
    v_bitop3_b32 v96, v88, v96, s15 bitop3:0xde
    v_bitop3_b32 v96, v89, v96, s15 bitop3:0xde
    v_bitop3_b32 v96, v90, v96, s15 bitop3:0xde
    v_bitop3_b32 v96, v91, v96, s15 bitop3:0xde
    v_bitop3_b32 v96, v92, v96, s15 bitop3:0xde
    v_bitop3_b32 v96, v93, v96, s15 bitop3:0xde
    v_bitop3_b32 v96, v94, v96, s15 bitop3:0xde
    v_bitop3_b32 v96, v95, v96, s15 bitop3:0xde
    s_mov_b32 exec_lo, 0x80008000
    s_mov_b32 exec_hi, 0x80008000
    v_cmp_ne_u32 vcc, 0, v96
    s_mov_b64 exec, -1
    s_cbranch_vccz L_b2_yok
    s_nop 0
    s_mov_b32 s14, 200000
L_poll2:
    buffer_load_dword v80, v4, s[52:55], s72 offen offset:0 sc1
    buffer_load_dword v81, v4, s[52:55], s72 offen offset:256 sc1
    buffer_load_dword v82, v4, s[52:55], s72 offen offset:512 sc1
    buffer_load_dword v83, v4, s[52:55], s72 offen offset:768 sc1
    buffer_load_dword v84, v4, s[52:55], s72 offen offset:1024 sc1
    buffer_load_dword v85, v4, s[52:55], s72 offen offset:1280 sc1
    buffer_load_dword v86, v4, s[52:55], s72 offen offset:1536 sc1
    buffer_load_dword v87, v4, s[52:55], s72 offen offset:1792 sc1
    buffer_load_dword v88, v4, s[52:55], s72 offen offset:2048 sc1
    buffer_load_dword v89, v4, s[52:55], s72 offen offset:2304 sc1
    buffer_load_dword v90, v4, s[52:55], s72 offen offset:2560 sc1
    buffer_load_dword v91, v4, s[52:55], s72 offen offset:2816 sc1
    buffer_load_dword v92, v4, s[52:55], s72 offen offset:3072 sc1
    buffer_load_dword v93, v4, s[52:55], s72 offen offset:3328 sc1
    buffer_load_dword v94, v4, s[52:55], s72 offen offset:3584 sc1
    buffer_load_dword v95, v4, s[52:55], s72 offen offset:3840 sc1
    s_sub_u32 s14, s14, 1
    s_waitcnt vmcnt(0)
    v_xor_b32_e64 v96, s15, v80
    v_bitop3_b32 v96, v81, v96, s15 bitop3:0xde
    v_bitop3_b32 v96, v82, v96, s15 bitop3:0xde
    v_bitop3_b32 v96, v83, v96, s15 bitop3:0xde
    v_bitop3_b32 v96, v84, v96, s15 bitop3:0xde
    v_bitop3_b32 v96, v85, v96, s15 bitop3:0xde
    v_bitop3_b32 v96, v86, v96, s15 bitop3:0xde
    v_bitop3_b32 v96, v87, v96, s15 bitop3:0xde
    v_bitop3_b32 v96, v88, v96, s15 bitop3:0xde
    v_bitop3_b32 v96, v89, v96, s15 bitop3:0xde
    v_bitop3_b32 v96, v90, v96, s15 bitop3:0xde
    v_bitop3_b32 v96, v91, v96, s15 bitop3:0xde
    v_bitop3_b32 v96, v92, v96, s15 bitop3:0xde
    v_bitop3_b32 v96, v93, v96, s15 bitop3:0xde
    v_bitop3_b32 v96, v94, v96, s15 bitop3:0xde
    v_bitop3_b32 v96, v95, v96, s15 bitop3:0xde
    s_mov_b32 exec_lo, 0x80008000
    s_mov_b32 exec_hi, 0x80008000
    v_cmp_ne_u32 vcc, 0, v96
    s_mov_b64 exec, -1
    s_cbranch_vccz L_pok2
    s_sleep 2
    s_cmp_lg_u32 s14, 0
    s_cbranch_scc1 L_poll2
L_pok2:
L_b2_yok:
    v_mfma_f32_16x16x32_bf16 v[96:99], v[16:19], v[80:83], 0
    v_mfma_f32_16x16x32_bf16 v[100:103], v[20:23], v[80:83], 0
    v_mfma_f32_16x16x32_bf16 v[104:107], v[24:27], v[84:87], 0
    v_mfma_f32_16x16x32_bf16 v[108:111], v[28:31], v[84:87], 0
    v_mfma_f32_16x16x32_bf16 v[112:115], v[32:35], v[88:91], 0
    v_mfma_f32_16x16x32_bf16 v[116:119], v[36:39], v[88:91], 0
    v_mfma_f32_16x16x32_bf16 v[120:123], v[40:43], v[92:95], 0
    v_mfma_f32_16x16x32_bf16 v[124:127], v[44:47], v[92:95], 0
    s_nop 1
    s_nop 0
    v_cvt_pk_bf16_f32 v80, v96, v100
    v_cvt_pk_bf16_f32 v81, v97, v101
    v_cvt_pk_bf16_f32 v82, v98, v102
    v_cvt_pk_bf16_f32 v83, v99, v103
    ds_write2st64_b32 v2, v80, v81 offset0:0 offset1:5
    ds_write2st64_b32 v2, v82, v83 offset0:10 offset1:15
    v_add_u32_e64 v2, 64, v2
    v_cvt_pk_bf16_f32 v84, v104, v108
    v_cvt_pk_bf16_f32 v85, v105, v109
    v_cvt_pk_bf16_f32 v86, v106, v110
    v_cvt_pk_bf16_f32 v87, v107, v111
    ds_write2st64_b32 v2, v84, v85 offset0:0 offset1:5
    ds_write2st64_b32 v2, v86, v87 offset0:10 offset1:15
    v_add_u32_e64 v2, 64, v2
    v_cvt_pk_bf16_f32 v88, v112, v116
    v_cvt_pk_bf16_f32 v89, v113, v117
    v_cvt_pk_bf16_f32 v90, v114, v118
    v_cvt_pk_bf16_f32 v91, v115, v119
    ds_write2st64_b32 v2, v88, v89 offset0:0 offset1:5
    ds_write2st64_b32 v2, v90, v91 offset0:10 offset1:15
    v_add_u32_e64 v2, 64, v2
    v_cvt_pk_bf16_f32 v92, v120, v124
    v_cvt_pk_bf16_f32 v93, v121, v125
    v_cvt_pk_bf16_f32 v94, v122, v126
    v_cvt_pk_bf16_f32 v95, v123, v127
    ds_write2st64_b32 v2, v92, v93 offset0:0 offset1:5
    ds_write2st64_b32 v2, v94, v95 offset0:10 offset1:15
    s_waitcnt lgkmcnt(0)
    s_barrier
    ds_read2_b32 v[80:81], v7 offset0:0 offset1:16
    ds_read2_b32 v[82:83], v7 offset0:32 offset1:48
    v_add_u32 v7, 1280, v7
    ds_read2_b32 v[84:85], v7 offset0:0 offset1:16
    ds_read2_b32 v[86:87], v7 offset0:32 offset1:48
    v_add_u32 v7, 1280, v7
    ds_read2_b32 v[88:89], v7 offset0:0 offset1:16
    ds_read2_b32 v[90:91], v7 offset0:32 offset1:48
    v_add_u32 v7, 1280, v7
    ds_read2_b32 v[92:93], v7 offset0:0 offset1:16
    ds_read2_b32 v[94:95], v7 offset0:32 offset1:48
    v_add_u32 v7, 1280, v7
    s_waitcnt lgkmcnt(6)
    v_mfma_f32_16x16x32_bf16 v[96:99], v[8:11], v[80:83], 0
    v_mfma_f32_16x16x32_bf16 v[100:103], v[12:15], v[80:83], 0
    s_waitcnt lgkmcnt(4)
    v_mfma_f32_16x16x32_bf16 v[104:107], v[8:11], v[84:87], 0
    v_mfma_f32_16x16x32_bf16 v[108:111], v[12:15], v[84:87], 0
    s_waitcnt lgkmcnt(2)
    v_mfma_f32_16x16x32_bf16 v[112:115], v[8:11], v[88:91], 0
    v_mfma_f32_16x16x32_bf16 v[116:119], v[12:15], v[88:91], 0
    s_waitcnt lgkmcnt(0)
    v_mfma_f32_16x16x32_bf16 v[120:123], v[8:11], v[92:95], 0
    v_mfma_f32_16x16x32_bf16 v[124:127], v[12:15], v[92:95], 0
    v_mul_f32 v80, v96, v48
    v_mul_f32 v96, v96, v52
    v_mul_f32 v81, v97, v49
    v_mul_f32 v97, v97, v53
    v_mul_f32 v82, v98, v50
    v_mul_f32 v98, v98, v54
    v_mul_f32 v83, v99, v51
    v_mul_f32 v99, v99, v55
    v_fma_f32 v80, -v100, v52, v80
    v_fmac_f32 v96, v100, v48
    v_fma_f32 v81, -v101, v53, v81
    v_fmac_f32 v97, v101, v49
    v_fma_f32 v82, -v102, v54, v82
    v_fmac_f32 v98, v102, v50
    v_fma_f32 v83, -v103, v55, v83
    v_fmac_f32 v99, v103, v51
    v_cvt_pk_bf16_f32 v80, v80, -v96
    v_cvt_pk_bf16_f32 v81, v81, -v97
    v_cvt_pk_bf16_f32 v82, v82, -v98
    v_cvt_pk_bf16_f32 v83, v83, -v99
    s_nop 1
    v_mfma_f32_16x16x32_bf16 v[96:99], v[16:19], v[80:83], 0
    v_mfma_f32_16x16x32_bf16 v[100:103], v[20:23], v[80:83], 0
    v_mul_f32 v84, v104, v56
    v_mul_f32 v104, v104, v60
    v_mul_f32 v85, v105, v57
    v_mul_f32 v105, v105, v61
    v_mul_f32 v86, v106, v58
    v_mul_f32 v106, v106, v62
    v_mul_f32 v87, v107, v59
    v_mul_f32 v107, v107, v63
    v_fma_f32 v84, -v108, v60, v84
    v_fmac_f32 v104, v108, v56
    v_fma_f32 v85, -v109, v61, v85
    v_fmac_f32 v105, v109, v57
    v_fma_f32 v86, -v110, v62, v86
    v_fmac_f32 v106, v110, v58
    v_fma_f32 v87, -v111, v63, v87
    v_fmac_f32 v107, v111, v59
    v_cvt_pk_bf16_f32 v84, v84, -v104
    v_cvt_pk_bf16_f32 v85, v85, -v105
    v_cvt_pk_bf16_f32 v86, v86, -v106
    v_cvt_pk_bf16_f32 v87, v87, -v107
    s_nop 1
    v_mfma_f32_16x16x32_bf16 v[104:107], v[24:27], v[84:87], 0
    v_mfma_f32_16x16x32_bf16 v[108:111], v[28:31], v[84:87], 0
    v_mul_f32 v88, v112, v64
    v_mul_f32 v112, v112, v68
    v_mul_f32 v89, v113, v65
    v_mul_f32 v113, v113, v69
    v_mul_f32 v90, v114, v66
    v_mul_f32 v114, v114, v70
    v_mul_f32 v91, v115, v67
    v_mul_f32 v115, v115, v71
    v_fma_f32 v88, -v116, v68, v88
    v_fmac_f32 v112, v116, v64
    v_fma_f32 v89, -v117, v69, v89
    v_fmac_f32 v113, v117, v65
    v_fma_f32 v90, -v118, v70, v90
    v_fmac_f32 v114, v118, v66
    v_fma_f32 v91, -v119, v71, v91
    v_fmac_f32 v115, v119, v67
    v_cvt_pk_bf16_f32 v88, v88, -v112
    v_cvt_pk_bf16_f32 v89, v89, -v113
    v_cvt_pk_bf16_f32 v90, v90, -v114
    v_cvt_pk_bf16_f32 v91, v91, -v115
    s_nop 1
    v_mfma_f32_16x16x32_bf16 v[112:115], v[32:35], v[88:91], 0
    v_mfma_f32_16x16x32_bf16 v[116:119], v[36:39], v[88:91], 0
    v_mul_f32 v92, v120, v72
    v_mul_f32 v120, v120, v76
    v_mul_f32 v93, v121, v73
    v_mul_f32 v121, v121, v77
    v_mul_f32 v94, v122, v74
    v_mul_f32 v122, v122, v78
    v_mul_f32 v95, v123, v75
    v_mul_f32 v123, v123, v79
    v_fma_f32 v92, -v124, v76, v92
    v_fmac_f32 v120, v124, v72
    v_fma_f32 v93, -v125, v77, v93
    v_fmac_f32 v121, v125, v73
    v_fma_f32 v94, -v126, v78, v94
    v_fmac_f32 v122, v126, v74
    v_fma_f32 v95, -v127, v79, v95
    v_fmac_f32 v123, v127, v75
    v_cvt_pk_bf16_f32 v92, v92, -v120
    v_cvt_pk_bf16_f32 v93, v93, -v121
    v_cvt_pk_bf16_f32 v94, v94, -v122
    v_cvt_pk_bf16_f32 v95, v95, -v123
    s_nop 1
    v_mfma_f32_16x16x32_bf16 v[120:123], v[40:43], v[92:95], 0
    v_mfma_f32_16x16x32_bf16 v[124:127], v[44:47], v[92:95], 0
    v_subrev_u32 v7, 5120, v7
    v_cvt_pk_bf16_f32 v80, v96, v100
    v_cvt_pk_bf16_f32 v81, v97, v101
    v_cvt_pk_bf16_f32 v82, v98, v102
    v_cvt_pk_bf16_f32 v83, v99, v103
    ds_write2_b32 v7, v80, v81 offset0:0 offset1:16
    ds_write2_b32 v7, v82, v83 offset0:32 offset1:48
    v_add_u32 v7, 1280, v7
    v_cvt_pk_bf16_f32 v84, v104, v108
    v_cvt_pk_bf16_f32 v85, v105, v109
    v_cvt_pk_bf16_f32 v86, v106, v110
    v_cvt_pk_bf16_f32 v87, v107, v111
    ds_write2_b32 v7, v84, v85 offset0:0 offset1:16
    ds_write2_b32 v7, v86, v87 offset0:32 offset1:48
    v_add_u32 v7, 1280, v7
    v_cvt_pk_bf16_f32 v88, v112, v116
    v_cvt_pk_bf16_f32 v89, v113, v117
    v_cvt_pk_bf16_f32 v90, v114, v118
    v_cvt_pk_bf16_f32 v91, v115, v119
    ds_write2_b32 v7, v88, v89 offset0:0 offset1:16
    ds_write2_b32 v7, v90, v91 offset0:32 offset1:48
    v_add_u32 v7, 1280, v7
    v_cvt_pk_bf16_f32 v92, v120, v124
    v_cvt_pk_bf16_f32 v93, v121, v125
    v_cvt_pk_bf16_f32 v94, v122, v126
    v_cvt_pk_bf16_f32 v95, v123, v127
    ds_write2_b32 v7, v92, v93 offset0:0 offset1:16
    ds_write2_b32 v7, v94, v95 offset0:32 offset1:48
    v_mov_b32 v48, s15
    v_mov_b32 v49, s15
    v_mov_b32 v50, s15
    v_mov_b32 v51, s15
    v_mov_b32 v52, s15
    v_mov_b32 v53, s15
    v_mov_b32 v54, s15
    v_mov_b32 v55, s15
    v_mov_b32 v56, s15
    v_mov_b32 v57, s15
    v_mov_b32 v58, s15
    v_mov_b32 v59, s15
    v_mov_b32 v60, s15
    v_mov_b32 v61, s15
    v_mov_b32 v62, s15
    v_mov_b32 v63, s15
    s_waitcnt lgkmcnt(0)
    s_barrier
    ds_read2st64_b32 v[92:93], v2 offset0:0 offset1:5
    ds_read2st64_b32 v[94:95], v2 offset0:10 offset1:15
    v_subrev_u32 v2, 64, v2
    ds_read2st64_b32 v[88:89], v2 offset0:0 offset1:5
    ds_read2st64_b32 v[90:91], v2 offset0:10 offset1:15
    v_subrev_u32 v2, 64, v2
    ds_read2st64_b32 v[84:85], v2 offset0:0 offset1:5
    ds_read2st64_b32 v[86:87], v2 offset0:10 offset1:15
    v_subrev_u32 v2, 64, v2
    ds_read2st64_b32 v[80:81], v2 offset0:0 offset1:5
    ds_read2st64_b32 v[82:83], v2 offset0:10 offset1:15
    s_waitcnt lgkmcnt(6)
    v_mfma_f32_16x16x32_bf16 v[120:123], v[8:11], v[92:95], 0
    v_mfma_f32_16x16x32_bf16 v[124:127], v[12:15], v[92:95], 0
    s_waitcnt lgkmcnt(4)
    v_mfma_f32_16x16x32_bf16 v[112:115], v[8:11], v[88:91], 0
    v_mfma_f32_16x16x32_bf16 v[116:119], v[12:15], v[88:91], 0
    s_waitcnt lgkmcnt(2)
    v_mfma_f32_16x16x32_bf16 v[104:107], v[8:11], v[84:87], 0
    v_mfma_f32_16x16x32_bf16 v[108:111], v[12:15], v[84:87], 0
    s_waitcnt lgkmcnt(0)
    s_nop 0
    v_mfma_f32_16x16x32_bf16 v[96:99], v[8:11], v[80:83], 0
    v_mfma_f32_16x16x32_bf16 v[100:103], v[12:15], v[80:83], 0
    s_mov_b32 exec_lo, 0x7fff7fff
    s_mov_b32 exec_hi, 0x7fff7fff
    v_cvt_pk_bf16_f32 v60, v120, -v124
    v_cvt_pk_bf16_f32 v61, v121, -v125
    v_cvt_pk_bf16_f32 v62, v122, -v126
    v_cvt_pk_bf16_f32 v63, v123, -v127
    s_mov_b64 exec, -1
    s_nop 0
    s_add_u32 s9, s8, 31104
    buffer_store_dword v60, v1, s[56:59], s9 offen sc1
    s_add_u32 s9, s8, 196992
    buffer_store_dword v61, v1, s[56:59], s9 offen sc1
    s_add_u32 s9, s8, 362880
    buffer_store_dword v62, v1, s[56:59], s9 offen sc1
    s_add_u32 s9, s8, 528768
    buffer_store_dword v63, v1, s[56:59], s9 offen sc1
    s_mov_b32 exec_lo, 0x7fff7fff
    s_mov_b32 exec_hi, 0x7fff7fff
    v_cvt_pk_bf16_f32 v56, v112, -v116
    v_cvt_pk_bf16_f32 v57, v113, -v117
    v_cvt_pk_bf16_f32 v58, v114, -v118
    v_cvt_pk_bf16_f32 v59, v115, -v119
    s_mov_b64 exec, -1
    s_nop 0
    s_add_u32 s9, s8, 20736
    buffer_store_dword v56, v1, s[56:59], s9 offen sc1
    s_add_u32 s9, s8, 186624
    buffer_store_dword v57, v1, s[56:59], s9 offen sc1
    s_add_u32 s9, s8, 352512
    buffer_store_dword v58, v1, s[56:59], s9 offen sc1
    s_add_u32 s9, s8, 518400
    buffer_store_dword v59, v1, s[56:59], s9 offen sc1
    s_mov_b32 exec_lo, 0x7fff7fff
    s_mov_b32 exec_hi, 0x7fff7fff
    v_cvt_pk_bf16_f32 v52, v104, -v108
    v_cvt_pk_bf16_f32 v53, v105, -v109
    v_cvt_pk_bf16_f32 v54, v106, -v110
    v_cvt_pk_bf16_f32 v55, v107, -v111
    s_mov_b64 exec, -1
    s_nop 0
    s_add_u32 s9, s8, 10368
    buffer_store_dword v52, v1, s[56:59], s9 offen sc1
    s_add_u32 s9, s8, 176256
    buffer_store_dword v53, v1, s[56:59], s9 offen sc1
    s_add_u32 s9, s8, 342144
    buffer_store_dword v54, v1, s[56:59], s9 offen sc1
    s_add_u32 s9, s8, 508032
    buffer_store_dword v55, v1, s[56:59], s9 offen sc1
    s_mov_b32 exec_lo, 0x7fff7fff
    s_mov_b32 exec_hi, 0x7fff7fff
    v_cvt_pk_bf16_f32 v48, v96, -v100
    v_cvt_pk_bf16_f32 v49, v97, -v101
    v_cvt_pk_bf16_f32 v50, v98, -v102
    v_cvt_pk_bf16_f32 v51, v99, -v103
    s_mov_b64 exec, -1
    s_add_u32 s9, s8, 0
    buffer_store_dword v48, v1, s[56:59], s9 offen sc1
    s_add_u32 s9, s8, 165888
    buffer_store_dword v49, v1, s[56:59], s9 offen sc1
    s_add_u32 s9, s8, 331776
    buffer_store_dword v50, v1, s[56:59], s9 offen sc1
    s_add_u32 s9, s8, 497664
    buffer_store_dword v51, v1, s[56:59], s9 offen sc1
    v_and_b32 v2, 15, v0
    v_lshrrev_b32 v3, 4, v0
    v_cvt_f32_u32 v4, v2
    v_cvt_f32_u32 v5, v3
    s_barrier
L_b3:
    s_nop 1
    s_setprio 0
    s_mov_b32 s68, s40
    s_mov_b32 s69, s41
    s_mov_b32 s70, 4718592
    s_mov_b32 s71, 0x20000
    s_cmp_lt_u32 s3, 2
    s_cselect_b32 s47, 512, 0
    s_lshl_b32 s8, s3, 7
    s_mul_i32 s76, s2, 10368
    s_add_u32 s76, s76, s8
    s_add_u32 s77, s76, 512
    s_add_u32 s47, s47, s77
    s_mul_i32 s75, s3, 4160
    v_and_b32 v82, 31, v0
    v_lshrrev_b32 v7, 5, v0
    v_mul_u32_u24 v1, 5120, v7
    v_lshl_add_u32 v1, v82, 2, v1
    v_cmp_lt_u32 vcc, 15, v82
    s_nop 1
    v_subbrev_co_u32 v82, vcc, 0, v82, vcc
    s_mul_i32 s8, s3, 120
    v_lshlrev_b32 v6, 2, v82
    v_add_u32 v6, s8, v6
    v_bfe_u32 v84, v0, 1, 4
    v_cvt_f32_u32 v84, v84
    v_lshrrev_b32 v85, 5, v0
    v_cvt_f32_u32 v85, v85
    v_and_b32 v86, 1, v0
    v_cvt_f32_u32 v86, v86
    v_mul_f32 v86, 0x3e800000, v86
    v_cvt_f32_u32 v87, s2
    v_mul_f32 v87, 0x3a000000, v87
    v_fmac_f32 v87, 0x3e000000, v84
    v_sub_f32 v87, 0, v87
    v_mul_f32 v85, 4.0, v85
    v_fma_f32 v86, v85, v87, v86
    v_mov_b32 v88, v86
    v_add_f32 v89, v86, v87
    v_fmamk_f32 v90, v87, 0x40000000, v86
    v_fmamk_f32 v91, v87, 0x40400000, v86
    v_cos_f32 v92, v88
    v_cos_f32 v93, v89
    v_cos_f32 v94, v90
    v_cos_f32 v95, v91
    v_sin_f32 v96, v88
    v_sin_f32 v97, v89
    v_sin_f32 v98, v90
    v_sin_f32 v99, v91
    v_cvt_pk_bf16_f32 v64, v92, v96
    v_cvt_pk_bf16_f32 v65, v93, v97
    v_cvt_pk_bf16_f32 v66, v94, v98
    v_cvt_pk_bf16_f32 v67, v95, v99
    v_and_b32 v85, 12, v2
    v_add_u32 v85, v85, v2
    v_cvt_f32_u32 v84, v85
    v_mul_f32 v85, 4.0, v5
    v_and_b32 v86, 1, v0
    v_mul_u32_u24 v86, 0x8000, v86
    v_lshl_or_b32 v86, v86, 16, v86
    v_xor_b32 v86, 0x80000000, v86
    v_mul_f32 v87, 0x3d000000, v84
    v_mul_f32 v88, v85, v87
    v_mov_b32 v89, v88
    v_add_f32 v90, v88, v87
    v_fmamk_f32 v91, v87, 0x40000000, v88
    v_fmamk_f32 v92, v87, 0x40400000, v88
    v_cos_f32 v93, v89
    v_cos_f32 v94, v90
    v_cos_f32 v95, v91
    v_cos_f32 v96, v92
    v_sin_f32 v97, v89
    v_sin_f32 v98, v90
    v_sin_f32 v99, v91
    v_sin_f32 v100, v92
    v_cvt_pk_bf16_f32 v8, v93, -v97
    v_cvt_pk_bf16_f32 v24, v97, v93
    v_cvt_pk_bf16_f32 v9, v94, -v98
    v_cvt_pk_bf16_f32 v25, v98, v94
    v_cvt_pk_bf16_f32 v10, v95, -v99
    v_cvt_pk_bf16_f32 v26, v99, v95
    v_cvt_pk_bf16_f32 v11, v96, -v100
    v_cvt_pk_bf16_f32 v27, v100, v96
    v_xor_b32 v16, v86, v8
    v_xor_b32 v32, v86, v24
    v_xor_b32 v17, v86, v9
    v_xor_b32 v33, v86, v25
    v_xor_b32 v18, v86, v10
    v_xor_b32 v34, v86, v26
    v_xor_b32 v19, v86, v11
    v_xor_b32 v35, v86, v27
    v_mul_f32 v87, 0x3ae38e39, v84
    v_mul_f32 v88, v85, v87
    v_mov_b32 v89, v88
    v_add_f32 v90, v88, v87
    v_fmamk_f32 v91, v87, 0x40000000, v88
    v_fmamk_f32 v92, v87, 0x40400000, v88
    v_cos_f32 v40, v89
    v_cos_f32 v41, v90
    v_cos_f32 v42, v91
    v_cos_f32 v43, v92
    v_sin_f32 v48, v89
    v_sin_f32 v49, v90
    v_sin_f32 v50, v91
    v_sin_f32 v51, v92
    v_add_f32 v84, 4.0, v84
    v_mul_f32 v87, 0x3d000000, v84
    v_mul_f32 v88, v85, v87
    v_mov_b32 v89, v88
    v_add_f32 v90, v88, v87
    v_fmamk_f32 v91, v87, 0x40000000, v88
    v_fmamk_f32 v92, v87, 0x40400000, v88
    v_cos_f32 v93, v89
    v_cos_f32 v94, v90
    v_cos_f32 v95, v91
    v_cos_f32 v96, v92
    v_sin_f32 v97, v89
    v_sin_f32 v98, v90
    v_sin_f32 v99, v91
    v_sin_f32_e64 v100, v92
    v_cvt_pk_bf16_f32 v12, v93, -v97
    v_cvt_pk_bf16_f32 v28, v97, v93
    v_cvt_pk_bf16_f32 v13, v94, -v98
    v_cvt_pk_bf16_f32 v29, v98, v94
    v_cvt_pk_bf16_f32 v14, v95, -v99
    v_cvt_pk_bf16_f32 v30, v99, v95
    v_cvt_pk_bf16_f32 v15, v96, -v100
    v_cvt_pk_bf16_f32 v31, v100, v96
    v_xor_b32 v20, v86, v12
    v_xor_b32 v36, v86, v28
    v_xor_b32 v21, v86, v13
    v_xor_b32 v37, v86, v29
    v_xor_b32 v22, v86, v14
    v_xor_b32 v38, v86, v30
    v_xor_b32 v23, v86, v15
    v_xor_b32 v39, v86, v31
    v_mul_f32 v87, 0x3ae38e39, v84
    v_mul_f32 v88, v85, v87
    v_mov_b32 v89, v88
    v_add_f32 v90, v88, v87
    v_fmamk_f32 v91, v87, 0x40000000, v88
    v_fmamk_f32 v92, v87, 0x40400000, v88
    v_cos_f32 v44, v89
    v_cos_f32 v45, v90
    v_cos_f32 v46, v91
    v_cos_f32 v47, v92
    v_sin_f32 v52, v89
    v_sin_f32 v53, v90
    v_sin_f32 v54, v91
    v_sin_f32 v55, v92
    s_cmp_lt_u32 s2, 96
    s_cbranch_scc1 L_b3_noearly
    s_waitcnt vmcnt(0)
    s_nop 0
    buffer_load_dword v68, v1, s[56:59], s76 offen offset:0 sc1
    buffer_load_dword v69, v1, s[56:59], s76 offen offset:1280 sc1
    buffer_load_dword v70, v1, s[56:59], s76 offen offset:2560 sc1
    buffer_load_dword v71, v1, s[56:59], s76 offen offset:3840 sc1
    buffer_load_dword v72, v1, s[56:59], s77 offen offset:0 sc1
    buffer_load_dword v73, v1, s[56:59], s77 offen offset:1280 sc1
    buffer_load_dword v74, v1, s[56:59], s77 offen offset:2560 sc1
    buffer_load_dword v75, v1, s[56:59], s77 offen offset:3840 sc1
    buffer_load_dword v76, v1, s[56:59], s47 offen offset:0 sc1
    buffer_load_dword v77, v1, s[56:59], s47 offen offset:1280 sc1
    buffer_load_dword v78, v1, s[56:59], s47 offen offset:2560 sc1
    buffer_load_dword v79, v1, s[56:59], s47 offen offset:3840 sc1
L_b3_noearly:
    v_mov_b32 v101, 0x35e38e39
    v_mov_b32 v102, 0x35e38e39
    v_mov_b32 v103, 0x35e38e39
    v_mov_b32 v104, 0x35e38e39
    s_mov_b64 exec, 0xffff
    v_mov_b32 v101, 0x35638e39
    s_mov_b32 exec_lo, 0
    s_mov_b32 exec_hi, -1
    v_mov_b32 v102, 0x35638e39
    v_mov_b32 v103, 0
    v_mov_b32 v104, 0
    s_mov_b32 exec_hi, 0xffff0000
    v_mov_b32 v101, 0
    v_mov_b32 v102, 0
    s_mov_b64 exec, -1
    v_mul_f32 v87, 0x3d638e39, v4
    v_mul_f32 v88, v85, v87
    v_mov_b32 v89, v88
    v_add_f32 v90, v88, v87
    v_fmamk_f32 v91, v87, 0x40000000, v88
    v_fmamk_f32 v92, v87, 0x40400000, v88
    v_cos_f32 v93, v89
    v_cos_f32 v94, v90
    v_cos_f32 v95, v91
    v_cos_f32 v96, v92
    v_sin_f32 v97, v89
    v_sin_f32 v98, v90
    v_sin_f32 v99, v91
    v_sin_f32 v100, v92
    v_mul_f32 v93, v101, v93
    v_mul_f32 v97, v101, v97
    v_cvt_pk_bf16_f32 v56, v93, -v97
    v_mul_f32 v94, v102, v94
    v_mul_f32 v98, v102, v98
    v_cvt_pk_bf16_f32 v57, v94, -v98
    v_mul_f32 v95, v103, v95
    v_mul_f32 v99, v103, v99
    v_cvt_pk_bf16_f32 v58, v95, -v99
    v_mul_f32 v96, v104, v96
    v_mul_f32 v100, v104, v100
    v_cvt_pk_bf16_f32 v59, v96, -v100
    v_add_f32 v87, 0x3f638e39, v87
    v_mul_f32 v88, v85, v87
    v_mov_b32 v89, v88
    v_add_f32 v90, v88, v87
    v_fmamk_f32 v91, v87, 0x40000000, v88
    v_fmamk_f32 v92, v87, 0x40400000, v88
    v_cos_f32 v93, v89
    v_cos_f32 v94, v90
    v_cos_f32 v95, v91
    v_cos_f32 v96, v92
    v_sin_f32 v97, v89
    v_sin_f32 v98, v90
    v_sin_f32 v99, v91
    v_sin_f32 v100, v92
    v_mul_f32 v93, v101, v93
    v_mul_f32 v97, v101, v97
    v_cvt_pk_bf16_f32 v60, v93, -v97
    v_mul_f32 v94, v102, v94
    v_mul_f32 v98, v102, v98
    v_cvt_pk_bf16_f32 v61, v94, -v98
    v_mul_f32 v95, v103, v95
    v_mul_f32 v99, v103, v99
    v_cvt_pk_bf16_f32 v62, v95, -v99
    v_mul_f32 v96, v104, v96
    v_mul_f32 v100, v104, v100
    v_cvt_pk_bf16_f32 v63, v96, -v100
    v_mul_u32_u24 v124, 2560, v7
    v_add_u32 v124, v124, v6
    v_cmp_eq_u32 vcc, 15, v2
    v_lshlrev_b32 v84, 2, v0
    v_add_u32 v84, 10240, v84
    v_cndmask_b32 v124, v124, v84, vcc
    v_min_u32 v84, 9, v2
    v_mul_u32_u24 v85, 72, v3
    v_add_u32_e64 v84, v84, v85
    s_mul_i32 s7, s3, 2560
    s_add_u32 s7, s7, 19456
    v_lshl_add_u32 v125, v84, 2, s7
    v_sub_u32 v84, 234, v84
    v_lshl_add_u32 v126, v84, 2, s7
    v_add_u32 v118, 1280, v125
    v_add_u32 v119, 1280, v126
    v_lshlrev_b32 v127, 6, v2
    v_lshl_add_u32 v127, v3, 4, v127
    s_mul_i32 s12, s3, 1179648
    s_mul_i32 s13, s2, 2304
    s_add_u32 s12, s12, s13
    s_add_u32 s13, s12, 589824
    s_setprio 3
    s_cmp_ge_u32 s2, 96
    s_cbranch_scc1 L_b3_nogate
    s_mov_b64 exec, 0x8000
    s_mov_b32 s14, 200000
L_poll3:
    buffer_load_dword v84, v1, s[56:59], s76 offen sc1
    s_sub_u32 s14, s14, 1
    s_waitcnt vmcnt(0)
    v_cmp_ne_u32 vcc, s15, v84
    s_cbranch_vccz L_pok3
    s_sleep 2
    s_cmp_lg_u32 s14, 0
    s_cbranch_scc1 L_poll3
L_pok3:
    s_mov_b64 exec, -1
    s_sleep 4
    s_nop 0
    buffer_load_dword v68, v1, s[56:59], s76 offen offset:0 sc1
    buffer_load_dword v69, v1, s[56:59], s76 offen offset:1280 sc1
    buffer_load_dword v70, v1, s[56:59], s76 offen offset:2560 sc1
    buffer_load_dword v71, v1, s[56:59], s76 offen offset:3840 sc1
    buffer_load_dword v72, v1, s[56:59], s77 offen offset:0 sc1
    buffer_load_dword v73, v1, s[56:59], s77 offen offset:1280 sc1
    buffer_load_dword v74, v1, s[56:59], s77 offen offset:2560 sc1
    buffer_load_dword v75, v1, s[56:59], s77 offen offset:3840 sc1
    buffer_load_dword v76, v1, s[56:59], s47 offen offset:0 sc1
    buffer_load_dword v77, v1, s[56:59], s47 offen offset:1280 sc1
    buffer_load_dword v78, v1, s[56:59], s47 offen offset:2560 sc1
    buffer_load_dword v79, v1, s[56:59], s47 offen offset:3840 sc1
L_b3_nogate:
    s_waitcnt vmcnt(0)
    v_xor_b32 v82, s15, v68
    v_bitop3_b32 v82, v69, v82, s15 bitop3:0xde
    v_bitop3_b32 v82, v70, v82, s15 bitop3:0xde
    v_bitop3_b32 v82, v71, v82, s15 bitop3:0xde
    v_bitop3_b32 v82, v72, v82, s15 bitop3:0xde
    v_bitop3_b32 v82, v73, v82, s15 bitop3:0xde
    v_bitop3_b32 v82, v74, v82, s15 bitop3:0xde
    v_bitop3_b32 v82, v75, v82, s15 bitop3:0xde
    v_bitop3_b32 v82, v76, v82, s15 bitop3:0xde
    v_bitop3_b32 v82, v77, v82, s15 bitop3:0xde
    v_bitop3_b32 v82, v78, v82, s15 bitop3:0xde
    v_bitop3_b32 v82, v79, v82, s15 bitop3:0xde
    s_mov_b32 exec_lo, 0x80008000
    s_mov_b32 exec_hi, 0x80008000
    v_cmp_ne_u32 vcc, 0, v82
    s_mov_b64 exec, -1
    s_cbranch_vccz L_b3_zok
    s_nop 0
    s_mov_b32 s14, 200000
L_poll4:
    buffer_load_dword v68, v1, s[56:59], s76 offen offset:0 sc1
    buffer_load_dword v69, v1, s[56:59], s76 offen offset:1280 sc1
    buffer_load_dword v70, v1, s[56:59], s76 offen offset:2560 sc1
    buffer_load_dword v71, v1, s[56:59], s76 offen offset:3840 sc1
    buffer_load_dword v72, v1, s[56:59], s77 offen offset:0 sc1
    buffer_load_dword v73, v1, s[56:59], s77 offen offset:1280 sc1
    buffer_load_dword v74, v1, s[56:59], s77 offen offset:2560 sc1
    buffer_load_dword v75, v1, s[56:59], s77 offen offset:3840 sc1
    buffer_load_dword v76, v1, s[56:59], s47 offen offset:0 sc1
    buffer_load_dword v77, v1, s[56:59], s47 offen offset:1280 sc1
    buffer_load_dword v78, v1, s[56:59], s47 offen offset:2560 sc1
    buffer_load_dword v79, v1, s[56:59], s47 offen offset:3840 sc1
    s_sub_u32 s14, s14, 1
    s_waitcnt vmcnt(0)
    v_xor_b32_e64 v82, s15, v68
    v_bitop3_b32 v82, v69, v82, s15 bitop3:0xde
    v_bitop3_b32 v82, v70, v82, s15 bitop3:0xde
    v_bitop3_b32 v82, v71, v82, s15 bitop3:0xde
    v_bitop3_b32 v82, v72, v82, s15 bitop3:0xde
    v_bitop3_b32 v82, v73, v82, s15 bitop3:0xde
    v_bitop3_b32 v82, v74, v82, s15 bitop3:0xde
    v_bitop3_b32 v82, v75, v82, s15 bitop3:0xde
    v_bitop3_b32 v82, v76, v82, s15 bitop3:0xde
    v_bitop3_b32 v82, v77, v82, s15 bitop3:0xde
    v_bitop3_b32 v82, v78, v82, s15 bitop3:0xde
    v_bitop3_b32 v82, v79, v82, s15 bitop3:0xde
    s_mov_b32 exec_lo, 0x80008000
    s_mov_b32 exec_hi, 0x80008000
    v_cmp_ne_u32 vcc, 0, v82
    s_mov_b64 exec, -1
    s_cbranch_vccz L_pok4
    s_sleep 2
    s_cmp_lg_u32 s14, 0
    s_cbranch_scc1 L_poll4
L_pok4:
L_b3_zok:
    v_mfma_f32_32x32x16_bf16 v[84:99], v[64:67], v[68:71], 0
    v_mfma_f32_32x32x16_bf16 v[100:115], v[64:67], v[72:75], 0
    s_nop 10
    s_nop 0
    v_cvt_pk_bf16_f32 v68, v84, v85
    v_cvt_pk_bf16_f32 v69, v86, v87
    v_cvt_pk_bf16_f32 v70, v88, v89
    v_cvt_pk_bf16_f32 v71, v90, v91
    ds_write_b32 v124, v68 offset:19456
    ds_write_b32 v124, v69 offset:20736
    ds_write_b32 v124, v70 offset:24576
    ds_write_b32 v124, v71 offset:25856
    v_mfma_f32_32x32x16_bf16 v[84:99], v[64:67], v[76:79], 0
    v_cvt_pk_bf16_f32 v72, v100, v101
    v_cvt_pk_bf16_f32 v73, v102, v103
    v_cvt_pk_bf16_f32 v74, v104, v105
    v_cvt_pk_bf16_f32 v75, v106, v107
    ds_write_b32 v124, v72 offset:19936
    ds_write_b32 v124, v73 offset:21216
    ds_write_b32 v124, v74 offset:25056
    ds_write_b32 v124, v75 offset:26336
    s_cmp_ge_u32 s3, 2
    s_cbranch_scc1 L_b3_skip
    s_nop 1
    s_nop 0
    v_cvt_pk_bf16_f32 v76, v84, v85
    v_cvt_pk_bf16_f32 v77, v86, v87
    v_cvt_pk_bf16_f32 v78, v88, v89
    v_cvt_pk_bf16_f32 v79, v90, v91
    ds_write_b32 v124, v76 offset:20416
    ds_write_b32 v124, v77 offset:21696
    ds_write_b32 v124, v78 offset:25536
    ds_write_b32 v124, v79 offset:26816
L_b3_skip:
    s_waitcnt lgkmcnt(0)
    s_barrier
    ds_read2_b32 v[68:69], v125 offset0:0 offset1:18
    ds_read2_b32 v[70:71], v125 offset0:36 offset1:54
    ds_read2_b32 v[72:73], v126 offset0:54 offset1:36
    ds_read2_b32 v[74:75], v126 offset0:18 offset1:0
    ds_read2_b32 v[76:77], v118 offset0:0 offset1:18
    ds_read2_b32 v[78:79], v118 offset0:36 offset1:54
    ds_read2_b32 v[80:81], v119 offset0:54 offset1:36
    ds_read2_b32 v[82:83], v119 offset0:18 offset1:0
    s_waitcnt lgkmcnt(4)
    v_mfma_f32_16x16x32_bf16 v[84:87], v[68:71], v[8:11], 0
    v_mfma_f32_16x16x32_bf16 v[84:87], v[72:75], v[16:19], v[84:87]
    v_mfma_f32_16x16x32_bf16 v[88:91], v[68:71], v[24:27], 0
    v_mfma_f32_16x16x32_bf16 v[88:91], v[72:75], v[32:35], v[88:91]
    v_mfma_f32_16x16x32_bf16 v[92:95], v[68:71], v[12:15], 0
    v_mfma_f32_16x16x32_bf16 v[92:95], v[72:75], v[20:23], v[92:95]
    v_mfma_f32_16x16x32_bf16 v[96:99], v[68:71], v[28:31], 0
    v_mfma_f32_16x16x32_bf16 v[96:99], v[72:75], v[36:39], v[96:99]
    s_waitcnt lgkmcnt(0)
    v_mfma_f32_16x16x32_bf16 v[100:103], v[76:79], v[8:11], 0
    v_mfma_f32_16x16x32_bf16 v[100:103], v[80:83], v[16:19], v[100:103]
    v_mfma_f32_16x16x32_bf16 v[104:107], v[76:79], v[24:27], 0
    v_mfma_f32_16x16x32_bf16 v[104:107], v[80:83], v[32:35], v[104:107]
    v_mfma_f32_16x16x32_bf16 v[108:111], v[76:79], v[12:15], 0
    v_mfma_f32_16x16x32_bf16 v[108:111], v[80:83], v[20:23], v[108:111]
    v_mfma_f32_16x16x32_bf16 v[112:115], v[76:79], v[28:31], 0
    v_mfma_f32_16x16x32_bf16 v[112:115], v[80:83], v[36:39], v[112:115]
    v_pk_mul_f32 v[116:117], v[84:85], v[40:41]
    v_pk_mul_f32 v[120:121], v[88:89], v[40:41]
    v_pk_mul_f32 v[118:119], v[86:87], v[42:43]
    v_pk_mul_f32 v[122:123], v[90:91], v[42:43]
    v_pk_fma_f32 v[116:117], v[88:89], v[48:49], v[116:117] neg_lo:[0,1,0] neg_hi:[0,1,0]
    v_pk_fma_f32 v[120:121], v[84:85], v[48:49], v[120:121]
    v_pk_fma_f32 v[118:119], v[90:91], v[50:51], v[118:119] neg_lo:[0,1,0] neg_hi:[0,1,0]
    v_pk_fma_f32 v[122:123], v[86:87], v[50:51], v[122:123]
    v_cvt_pk_bf16_f32 v68, v116, v120
    v_cvt_pk_bf16_f32 v69, v117, v121
    v_cvt_pk_bf16_f32 v70, v118, v122
    v_cvt_pk_bf16_f32 v71, v119, v123
    v_pk_mul_f32 v[116:117], v[92:93], v[44:45]
    v_pk_mul_f32 v[120:121], v[96:97], v[44:45]
    v_pk_mul_f32 v[118:119], v[94:95], v[46:47]
    v_pk_mul_f32 v[122:123], v[98:99], v[46:47]
    v_pk_fma_f32 v[116:117], v[96:97], v[52:53], v[116:117] neg_lo:[0,1,0] neg_hi:[0,1,0]
    v_pk_fma_f32 v[120:121], v[92:93], v[52:53], v[120:121]
    v_pk_fma_f32 v[118:119], v[98:99], v[54:55], v[118:119] neg_lo:[0,1,0] neg_hi:[0,1,0]
    v_pk_fma_f32 v[122:123], v[94:95], v[54:55], v[122:123]
    v_cvt_pk_bf16_f32 v72, v116, v120
    v_cvt_pk_bf16_f32 v73, v117, v121
    v_cvt_pk_bf16_f32 v74, v118, v122
    v_cvt_pk_bf16_f32 v75, v119, v123
    v_mfma_f32_16x16x32_bf16 v[84:87], v[68:71], v[56:59], 0
    s_nop 0
    s_nop 0
    v_mfma_f32_16x16x32_bf16 v[88:91], v[72:75], v[56:59], 0
    v_mfma_f32_16x16x32_bf16 v[92:95], v[68:71], v[60:63], 0
    v_mfma_f32_16x16x32_bf16 v[96:99], v[72:75], v[60:63], 0
    v_pk_mul_f32 v[116:117], v[100:101], v[40:41]
    v_pk_mul_f32 v[120:121], v[104:105], v[40:41]
    v_pk_mul_f32 v[118:119], v[102:103], v[42:43]
    v_pk_mul_f32 v[122:123], v[106:107], v[42:43]
    v_pk_fma_f32 v[116:117], v[104:105], v[48:49], v[116:117] neg_lo:[0,1,0] neg_hi:[0,1,0]
    v_pk_fma_f32 v[120:121], v[100:101], v[48:49], v[120:121]
    v_pk_fma_f32 v[118:119], v[106:107], v[50:51], v[118:119] neg_lo:[0,1,0] neg_hi:[0,1,0]
    v_pk_fma_f32 v[122:123], v[102:103], v[50:51], v[122:123]
    v_cvt_pk_bf16_f32 v76, v116, v120
    v_cvt_pk_bf16_f32 v77, v117, v121
    v_cvt_pk_bf16_f32 v78, v118, v122
    v_cvt_pk_bf16_f32 v79, v119, v123
    v_pk_mul_f32 v[116:117], v[108:109], v[44:45]
    v_pk_mul_f32 v[120:121], v[112:113], v[44:45]
    v_pk_mul_f32 v[118:119], v[110:111], v[46:47]
    v_pk_mul_f32 v[122:123], v[114:115], v[46:47]
    v_pk_fma_f32 v[116:117], v[112:113], v[52:53], v[116:117] neg_lo:[0,1,0] neg_hi:[0,1,0]
    v_pk_fma_f32 v[120:121], v[108:109], v[52:53], v[120:121]
    v_pk_fma_f32 v[118:119], v[114:115], v[54:55], v[118:119] neg_lo:[0,1,0] neg_hi:[0,1,0]
    v_pk_fma_f32 v[122:123], v[110:111], v[54:55], v[122:123]
    v_cvt_pk_bf16_f32 v80, v116, v120
    v_cvt_pk_bf16_f32 v81, v117, v121
    v_cvt_pk_bf16_f32 v82, v118, v122
    v_cvt_pk_bf16_f32 v83, v119, v123
    v_mfma_f32_16x16x32_bf16 v[100:103], v[76:79], v[56:59], 0
    s_nop 0
    s_nop 0
    v_mfma_f32_16x16x32_bf16 v[104:107], v[80:83], v[56:59], 0
    v_mfma_f32_16x16x32_bf16 v[108:111], v[76:79], v[60:63], 0
    v_mfma_f32_16x16x32_bf16 v[112:115], v[80:83], v[60:63], 0
    v_cvt_pk_bf16_f32 v8, v84, v85
    v_cvt_pk_bf16_f32 v9, v86, v87
    v_cvt_pk_bf16_f32 v10, v88, v89
    v_cvt_pk_bf16_f32 v11, v90, v91
    v_cvt_pk_bf16_f32 v12, v92, v93
    v_cvt_pk_bf16_f32 v13, v94, v95
    v_cvt_pk_bf16_f32 v14, v96, v97
    v_cvt_pk_bf16_f32 v15, v98, v99
    buffer_store_dwordx4 v[8:11], v127, s[68:71], s12 offen offset:1152 sc1
    v_cvt_pk_bf16_f32 v16, v100, v101
    v_cvt_pk_bf16_f32 v17, v102, v103
    v_cvt_pk_bf16_f32 v18, v104, v105
    v_cvt_pk_bf16_f32 v19, v106, v107
    v_cvt_pk_bf16_f32 v20, v108, v109
    v_cvt_pk_bf16_f32 v21, v110, v111
    v_cvt_pk_bf16_f32 v22, v112, v113
    v_cvt_pk_bf16_f32 v23, v114, v115
    buffer_store_dwordx4 v[16:19], v127, s[68:71], s13 offen offset:1152 sc1
    s_mov_b32 exec_lo, 0x00030003
    s_mov_b32 exec_hi, 0x00030003
    buffer_store_dwordx4 v[12:15], v127, s[68:71], s12 offen offset:2176 sc1
    buffer_store_dwordx4 v[20:23], v127, s[68:71], s13 offen offset:2176 sc1
    s_endpgm
.p2align 6
L_concat_heads__ssm_conv_s4__spectral_gfnet__prompt_kernel_r1:
    s_cmp_lt_u32 s2, 832
    s_cbranch_scc1 L_concat_heads__ssm_conv_s4__spectral_gfnet__prompt_kernel_go
    s_endpgm
L_concat_heads__ssm_conv_s4__spectral_gfnet__prompt_kernel_go:
    s_sub_u32 s2, s2, 256
    s_mov_b32 s61, s2
    s_mov_b32 s62, 0
    s_and_b32 s4, s3, 1
    s_lshl_b32 s4, s4, 7
    s_lshl_b32 s5, s2, 8
    s_add_u32 s4, s4, s5
    v_lshl_add_u32 v1, v0, 1, s4
    s_lshl_b32 s6, s2, 1
    s_and_b32 s7, s6, 2
    s_and_b32 s6, s6, -4
    v_lshrrev_b32 v98, 3, v0
    v_and_b32 v99, 7, v0
    v_mul_u32_u24 v104, 1152, v98
    v_lshl_add_u32 v104, v99, 4, v104
    s_mul_i32 s46, s3, 1920
    s_mov_b32 m0, s46
    s_mov_b32 s63, 0
    s_add_u32 s64, s61, 4294967232
    s_sub_u32 s5, s61, 64
    s_cmp_lt_u32 s5, 192
    s_cbranch_scc1 L_task5
    s_add_u32 s64, s61, 4294967168
    s_sub_u32 s5, s61, 320
    s_cmp_ge_u32 s5, 123
    s_cbranch_scc1 L_a_nt0
L_task5:
    s_mul_i32 s5, s64, 1873
    s_lshr_b32 s5, s5, 16
    s_mul_i32 s65, s5, 35
    s_sub_u32 s65, s64, s65
    s_mov_b32 s64, s5
    s_mov_b32 s63, 1
    s_lshl_b32 s4, s65, 2
    s_add_u32 s4, s4, s3
    s_mul_i32 s4, s4, 17280
    s_lshl_b32 s5, s64, 7
    s_add_u32 s47, s4, s5
    s_add_u32 s60, s47, 9216
L_a_nt0:
    s_mov_b32 s50, 2359296
    s_mov_b32 s51, 0x20000
    s_waitcnt lgkmcnt(0)
    s_mov_b32 s48, s16
    s_mov_b32 s49, s17
    s_cmp_lg_u32 s63, 1
    s_cbranch_scc1 L_a_nt
    buffer_load_dwordx4 v104, s[48:51], s47 offen  lds
    s_add_u32 m0, s46, 1024
    s_mov_b32 exec_hi, 0xffffff
    buffer_load_dwordx4 v104, s[48:51], s60 offen  lds
    s_mov_b32 exec_hi, -1
L_a_nt:
    global_load_short_d16_hi v2, v1, s[18:19]
    global_load_short_d16_hi v3, v1, s[20:21]
    s_cmp_ge_u32 s3, 2
    s_cbranch_scc1 L_a_nobc
    global_load_short_d16_hi v4, v1, s[22:23]
    global_load_short_d16_hi v5, v1, s[24:25]
    global_load_short_d16_hi v6, v1, s[26:27]
    global_load_short_d16_hi v7, v1, s[28:29]
L_a_nobc:
    s_add_u32 s8, s30, s6
    s_addc_u32 s9, s31, 0
    s_add_u32 s10, s32, s6
    s_addc_u32 s11, s33, 0
    s_load_dword s12, s[8:9], 0
    s_load_dword s71, s[10:11], 0
    s_add_u32 s52, s44, 8388608
    s_addc_u32 s53, s45, 0
    s_mov_b32 s54, 2580480
    s_mov_b32 s55, 0x20000
    s_add_u32 s56, s44, 12582912
    s_addc_u32 s57, s45, 0
    s_mov_b32 s58, 2580480
    s_mov_b32 s59, 0x20000
    s_mul_i32 s67, s2, 4480
    s_lshl_b32 s68, s3, 10
    s_and_b32 s4, s3, 1
    s_lshl_b32 s4, s4, 13
    s_lshr_b32 s5, s3, 1
    s_lshl_b32 s5, s5, 14
    s_add_u32 s4, s4, s5
    v_and_b32 v8, 7, v0
    v_lshlrev_b32 v8, 4, v8
    v_lshl_add_u32 v8, v0, 7, v8
    v_add_u32 v8, s4, v8
    s_lshl_b32 s7, s7, 3
    s_waitcnt lgkmcnt(0)
    s_lshr_b32 s12, s12, s7
    s_lshl_b32 s12, s12, 16
    s_lshr_b32 s71, s71, s7
    s_lshl_b32 s71, s71, 16
    v_mov_b32 v9, 0x3fb8aa3b
    v_mul_f32 v10, s12, v9
    v_exp_f32 v10, v10
    s_nop 0
    v_cvt_pk_bf16_f32 v10, v10, v10
    v_and_b32 v10, 0xffff0000, v10
    s_setprio 2
    s_cmp_lg_u32 s63, 0
    s_cbranch_scc1 L_a_k
    s_waitcnt vmcnt(0)
L_a_k:
    s_cmp_eq_u32 s63, 0
    s_cbranch_scc1 L_a_skip1
    v_bfe_u32 v108, v0, 2, 2
    v_lshrrev_b32 v109, 4, v0
    v_lshl_add_u32 v108, v109, 4, v108
    v_lshlrev_b32 v108, 7, v108
    v_and_b32 v110, 3, v0
    v_lshl_add_u32 v108, v110, 3, v108
    s_lshl_b32 s13, s3, 5
    v_add_u32 v108, s13, v108
    s_mul_i32 s13, s3, 2304
    v_and_b32 v110, 15, v0
    v_mul_u32_u24 v110, 144, v110
    v_lshl_add_u32 v110, v109, 5, v110
    v_add_u32 v110, s13, v110
    v_mul_u32_u24 v111, 144, v98
    v_lshl_add_u32 v111, v99, 4, v111
    v_and_b32 v107, 4, v0
    v_sub_u32 v111, v111, v107
    s_add_u32 s13, s13, 8192
    v_add_u32 v111, s13, v111
    v_add_u32 v107, 1152, v111
    v_mul_u32_u24 v109, 4480, v98
    v_lshl_add_u32 v109, v99, 4, v109
    s_lshl_b32 s66, s64, 2
    s_add_u32 s66, s66, s3
    s_mul_i32 s66, s66, 71680
    s_lshl_b32 s5, s65, 7
    s_add_u32 s66, s66, s5
    s_add_u32 s13, s66, 35840
    s_load_dword s15, s[42:43], 0
    s_waitcnt vmcnt(0)
    s_barrier
    ds_read_b64_tr_b16 v[112:113], v108
    ds_read_b64_tr_b16 v[114:115], v108 offset:512
    ds_read_b64_tr_b16 v[116:117], v108 offset:1024
    ds_read_b64_tr_b16 v[118:119], v108 offset:1536
    s_waitcnt lgkmcnt(0)
    ds_write_b128 v110, v[112:115] offset:8192
    ds_write_b128 v110, v[116:119] offset:8208
    ds_read2_b32 v[120:121], v111 offset0:0 offset1:1
    ds_read2_b32 v[122:123], v111 offset0:2 offset1:3
    ds_read2_b32 v[124:125], v107 offset0:0 offset1:1
    ds_read2_b32 v[126:127], v107 offset0:2 offset1:3
    s_cmp_lg_u32 s15, 0
    s_cbranch_scc1 L_tok6
    s_mov_b32 s14, 200000
    v_mov_b32 v105, 0
L_tag6:
    global_load_dword v106, v105, s[42:43] sc1
    s_sub_u32 s14, s14, 1
    s_waitcnt vmcnt(0)
    v_readfirstlane_b32 s15, v106
    s_nop 1
    s_cmp_lg_u32 s15, 0
    s_cbranch_scc1 L_tok6
    s_cmp_lg_u32 s14, 0
    s_cbranch_scc1 L_tag6
L_tok6:
    s_mov_b32 exec_lo, 0x88888888
    s_mov_b32 exec_hi, 0x88888888
    s_waitcnt lgkmcnt(0)
    v_mov_b32 v123, s15
    v_mov_b32 v127, s15
    s_mov_b64 exec, -1
    buffer_store_dwordx4 v[120:123], v109, s[52:55], s66 offen sc1
    buffer_store_dwordx4 v[124:127], v109, s[52:55], s13 offen sc1
    s_barrier
    s_branch L_a_done1
L_a_skip1:
    s_load_dword s15, s[42:43], 0
L_a_done1:
    s_setprio 0
    v_mul_f32 v2, v10, v2
    v_mul_f32 v3, v10, v3
    v_mul_f32 v2, v9, v2
    v_mul_f32 v3, 0.15915494, v3
    s_cmp_ge_u32 s3, 2
    s_cbranch_scc1 L_kg_p
    v_exp_f32 v12, v2
    v_fract_f32 v13, v3
    v_cos_f32 v14, v13
    v_sin_f32 v13, v13
    v_mul_f32 v16, v12, v14
    v_mul_f32 v17, v12, v13
    v_mul_f32 v12, 0x43800000, v2
    v_mul_f32 v13, 0x43800000, v3
    v_exp_f32 v12, v12
    v_fract_f32 v13, v13
    v_cos_f32 v14, v13
    v_sin_f32 v13, v13
    v_mul_f32 v18, v12, v14
    v_mul_f32 v19, v12, v13
    v_mul_f32 v4, v10, v4
    v_mul_f32 v5, v10, v5
    v_pk_mul_f32 v[20:21], v[6:7], v[4:5] op_sel:[0,0] op_sel_hi:[1,0]
    v_pk_fma_f32 v[20:21], v[6:7], v[4:5], v[20:21] op_sel:[1,1,0] op_sel_hi:[0,1,1] neg_lo:[1,0,0]
    v_pk_mul_f32 v[22:23], v[20:21], v[16:17] op_sel:[0,0] op_sel_hi:[1,0]
    v_pk_fma_f32 v[22:23], v[20:21], v[16:17], v[22:23] op_sel:[1,1,0] op_sel_hi:[0,1,1] neg_lo:[1,0,0]
    v_pk_mul_f32 v[24:25], v[22:23], v[16:17] op_sel:[0,0] op_sel_hi:[1,0]
    v_pk_fma_f32 v[24:25], v[22:23], v[16:17], v[24:25] op_sel:[1,1,0] op_sel_hi:[0,1,1] neg_lo:[1,0,0]
    v_pk_mul_f32 v[26:27], v[24:25], v[16:17] op_sel:[0,0] op_sel_hi:[1,0]
    v_pk_fma_f32 v[26:27], v[24:25], v[16:17], v[26:27] op_sel:[1,1,0] op_sel_hi:[0,1,1] neg_lo:[1,0,0]
    v_pk_mul_f32 v[28:29], v[26:27], v[16:17] op_sel:[0,0] op_sel_hi:[1,0]
    v_pk_fma_f32 v[28:29], v[26:27], v[16:17], v[28:29] op_sel:[1,1,0] op_sel_hi:[0,1,1] neg_lo:[1,0,0]
    v_pk_mul_f32 v[30:31], v[28:29], v[16:17] op_sel:[0,0] op_sel_hi:[1,0]
    v_pk_fma_f32 v[30:31], v[28:29], v[16:17], v[30:31] op_sel:[1,1,0] op_sel_hi:[0,1,1] neg_lo:[1,0,0]
    v_pk_mul_f32 v[32:33], v[30:31], v[16:17] op_sel:[0,0] op_sel_hi:[1,0]
    v_pk_fma_f32 v[32:33], v[30:31], v[16:17], v[32:33] op_sel:[1,1,0] op_sel_hi:[0,1,1] neg_lo:[1,0,0]
    v_pk_mul_f32 v[34:35], v[32:33], v[16:17] op_sel:[0,0] op_sel_hi:[1,0]
    v_pk_fma_f32 v[34:35], v[32:33], v[16:17], v[34:35] op_sel:[1,1,0] op_sel_hi:[0,1,1] neg_lo:[1,0,0]
    v_pk_mul_f32 v[36:37], v[34:35], v[16:17] op_sel:[0,0] op_sel_hi:[1,0]
    v_pk_fma_f32 v[36:37], v[34:35], v[16:17], v[36:37] op_sel:[1,1,0] op_sel_hi:[0,1,1] neg_lo:[1,0,0]
    v_pk_mul_f32 v[38:39], v[20:21], v[18:19] op_sel:[0,0] op_sel_hi:[1,0]
    v_pk_fma_f32 v[38:39], v[20:21], v[18:19], v[38:39] op_sel:[1,1,0] op_sel_hi:[0,1,1] neg_lo:[1,0,0]
    v_pk_mul_f32 v[40:41], v[24:25], v[18:19] op_sel:[0,0] op_sel_hi:[1,0]
    v_pk_fma_f32 v[40:41], v[24:25], v[18:19], v[40:41] op_sel:[1,1,0] op_sel_hi:[0,1,1] neg_lo:[1,0,0]
    v_pk_mul_f32 v[42:43], v[28:29], v[18:19] op_sel:[0,0] op_sel_hi:[1,0]
    v_pk_fma_f32 v[42:43], v[28:29], v[18:19], v[42:43] op_sel:[1,1,0] op_sel_hi:[0,1,1] neg_lo:[1,0,0]
    v_pk_mul_f32 v[44:45], v[32:33], v[18:19] op_sel:[0,0] op_sel_hi:[1,0]
    v_pk_fma_f32 v[44:45], v[32:33], v[18:19], v[44:45] op_sel:[1,1,0] op_sel_hi:[0,1,1] neg_lo:[1,0,0]
    v_pk_mul_f32 v[46:47], v[36:37], v[18:19] op_sel:[0,0] op_sel_hi:[1,0]
    v_pk_fma_f32 v[46:47], v[36:37], v[18:19], v[46:47] op_sel:[1,1,0] op_sel_hi:[0,1,1] neg_lo:[1,0,0]
    v_pk_mul_f32 v[48:49], v[38:39], v[18:19] op_sel:[0,0] op_sel_hi:[1,0]
    v_pk_fma_f32 v[48:49], v[38:39], v[18:19], v[48:49] op_sel:[1,1,0] op_sel_hi:[0,1,1] neg_lo:[1,0,0]
    v_pk_mul_f32 v[50:51], v[42:43], v[18:19] op_sel:[0,0] op_sel_hi:[1,0]
    v_pk_fma_f32 v[50:51], v[42:43], v[18:19], v[50:51] op_sel:[1,1,0] op_sel_hi:[0,1,1] neg_lo:[1,0,0]
    v_pk_mul_f32 v[52:53], v[46:47], v[18:19] op_sel:[0,0] op_sel_hi:[1,0]
    v_pk_fma_f32 v[52:53], v[46:47], v[18:19], v[52:53] op_sel:[1,1,0] op_sel_hi:[0,1,1] neg_lo:[1,0,0]
    v_pk_mul_f32 v[54:55], v[48:49], v[18:19] op_sel:[0,0] op_sel_hi:[1,0]
    v_pk_fma_f32 v[54:55], v[48:49], v[18:19], v[54:55] op_sel:[1,1,0] op_sel_hi:[0,1,1] neg_lo:[1,0,0]
    v_pk_mul_f32 v[56:57], v[50:51], v[18:19] op_sel:[0,0] op_sel_hi:[1,0]
    v_pk_fma_f32 v[56:57], v[50:51], v[18:19], v[56:57] op_sel:[1,1,0] op_sel_hi:[0,1,1] neg_lo:[1,0,0]
    v_pk_mul_f32 v[58:59], v[52:53], v[18:19] op_sel:[0,0] op_sel_hi:[1,0]
    v_pk_fma_f32 v[58:59], v[52:53], v[18:19], v[58:59] op_sel:[1,1,0] op_sel_hi:[0,1,1] neg_lo:[1,0,0]
    v_pk_mul_f32 v[60:61], v[54:55], v[18:19] op_sel:[0,0] op_sel_hi:[1,0]
    v_pk_fma_f32 v[60:61], v[54:55], v[18:19], v[60:61] op_sel:[1,1,0] op_sel_hi:[0,1,1] neg_lo:[1,0,0]
    v_pk_mul_f32 v[62:63], v[58:59], v[18:19] op_sel:[0,0] op_sel_hi:[1,0]
    v_pk_fma_f32 v[62:63], v[58:59], v[18:19], v[62:63] op_sel:[1,1,0] op_sel_hi:[0,1,1] neg_lo:[1,0,0]
    v_pk_mul_f32 v[64:65], v[60:61], v[18:19] op_sel:[0,0] op_sel_hi:[1,0]
    v_pk_fma_f32 v[64:65], v[60:61], v[18:19], v[64:65] op_sel:[1,1,0] op_sel_hi:[0,1,1] neg_lo:[1,0,0]
    v_pk_mul_f32 v[66:67], v[62:63], v[18:19] op_sel:[0,0] op_sel_hi:[1,0]
    v_pk_fma_f32 v[66:67], v[62:63], v[18:19], v[66:67] op_sel:[1,1,0] op_sel_hi:[0,1,1] neg_lo:[1,0,0]
    v_pk_mul_f32 v[68:69], v[64:65], v[18:19] op_sel:[0,0] op_sel_hi:[1,0]
    v_pk_fma_f32 v[68:69], v[64:65], v[18:19], v[68:69] op_sel:[1,1,0] op_sel_hi:[0,1,1] neg_lo:[1,0,0]
    v_pk_mul_f32 v[70:71], v[66:67], v[18:19] op_sel:[0,0] op_sel_hi:[1,0]
    v_pk_fma_f32 v[70:71], v[66:67], v[18:19], v[70:71] op_sel:[1,1,0] op_sel_hi:[0,1,1] neg_lo:[1,0,0]
    v_pk_mul_f32 v[72:73], v[68:69], v[18:19] op_sel:[0,0] op_sel_hi:[1,0]
    v_pk_fma_f32 v[72:73], v[68:69], v[18:19], v[72:73] op_sel:[1,1,0] op_sel_hi:[0,1,1] neg_lo:[1,0,0]
    v_pk_mul_f32 v[74:75], v[70:71], v[18:19] op_sel:[0,0] op_sel_hi:[1,0]
    v_pk_fma_f32 v[74:75], v[70:71], v[18:19], v[74:75] op_sel:[1,1,0] op_sel_hi:[0,1,1] neg_lo:[1,0,0]
    v_cvt_pk_bf16_f32 v88, v20, v22
    v_cvt_pk_bf16_f32 v89, v24, v26
    v_cvt_pk_bf16_f32 v90, v38, v38
    v_cvt_pk_bf16_f32 v91, v40, v42
    ds_write_b128 v8, v[88:91]
    v_cvt_pk_bf16_f32 v92, v28, v30
    v_cvt_pk_bf16_f32 v93, v32, v34
    v_cvt_pk_bf16_f32 v94, v42, v42
    v_cvt_pk_bf16_f32 v95, v44, v46
    v_xor_b32_e64 v96, 16, v8
    ds_write_b128 v96, v[92:95]
    v_cvt_pk_bf16_f32 v88, v36, v48
    v_cvt_pk_bf16_f32 v89, v50, v52
    v_cvt_pk_bf16_f32 v90, v46, v54
    v_cvt_pk_bf16_f32 v91, v56, v58
    v_xor_b32_e64 v97, 32, v8
    ds_write_b128 v97, v[88:91]
    v_cvt_pk_bf16_f32 v92, v60, v62
    v_cvt_pk_bf16_f32 v93, v64, v66
    v_cvt_pk_bf16_f32 v94, v68, v70
    v_cvt_pk_bf16_f32 v95, v72, v74
    v_xor_b32_e64 v96, 48, v8
    ds_write_b128 v96, v[92:95]
    v_cvt_pk_bf16_f32 v88, v21, v23
    v_cvt_pk_bf16_f32 v89, v25, v27
    v_cvt_pk_bf16_f32 v90, v39, v39
    v_cvt_pk_bf16_f32 v91, v41, v43
    v_xor_b32_e64 v97, 64, v8
    ds_write_b128 v97, v[88:91]
    v_cvt_pk_bf16_f32 v92, v29, v31
    v_cvt_pk_bf16_f32 v93, v33, v35
    v_cvt_pk_bf16_f32 v94, v43, v43
    v_cvt_pk_bf16_f32 v95, v45, v47
    v_xor_b32 v96, 80, v8
    ds_write_b128 v96, v[92:95]
    v_cvt_pk_bf16_f32 v88, v37, v49
    v_cvt_pk_bf16_f32 v89, v51, v53
    v_cvt_pk_bf16_f32 v90, v47, v55
    v_cvt_pk_bf16_f32 v91, v57, v59
    v_xor_b32 v97, 96, v8
    ds_write_b128 v97, v[88:91]
    v_cvt_pk_bf16_f32 v92, v61, v63
    v_cvt_pk_bf16_f32 v93, v65, v67
    v_cvt_pk_bf16_f32 v94, v69, v71
    v_cvt_pk_bf16_f32 v95, v73, v75
    v_xor_b32 v96, 112, v8
    ds_write_b128 v96, v[92:95]
    s_branch L_kg_join
L_kg_p:
    v_mul_f32 v12, 0x41000000, v2
    v_mul_f32 v13, 0x41000000, v3
    v_exp_f32 v12, v12
    v_fract_f32 v13, v13
    v_cos_f32 v14, v13
    v_sin_f32 v13, v13
    v_mul_f32 v16, v12, v14
    v_mul_f32_e64 v17, -v12, v13
    v_mov_b32 v20, 1.0
    v_mov_b32 v21, 0
    v_mov_b32 v22, v16
    v_mov_b32 v23, v17
    v_pk_mul_f32 v[24:25], v[22:23], v[16:17] op_sel:[0,0] op_sel_hi:[1,0]
    v_pk_fma_f32 v[24:25], v[22:23], v[16:17], v[24:25] op_sel:[1,1,0] op_sel_hi:[0,1,1] neg_lo:[1,0,0]
    v_pk_mul_f32 v[26:27], v[24:25], v[16:17] op_sel:[0,0] op_sel_hi:[1,0]
    v_pk_fma_f32 v[26:27], v[24:25], v[16:17], v[26:27] op_sel:[1,1,0] op_sel_hi:[0,1,1] neg_lo:[1,0,0]
    v_pk_mul_f32 v[28:29], v[26:27], v[16:17] op_sel:[0,0] op_sel_hi:[1,0]
    v_pk_fma_f32 v[28:29], v[26:27], v[16:17], v[28:29] op_sel:[1,1,0] op_sel_hi:[0,1,1] neg_lo:[1,0,0]
    v_pk_mul_f32 v[30:31], v[28:29], v[16:17] op_sel:[0,0] op_sel_hi:[1,0]
    v_pk_fma_f32 v[30:31], v[28:29], v[16:17], v[30:31] op_sel:[1,1,0] op_sel_hi:[0,1,1] neg_lo:[1,0,0]
    v_pk_mul_f32 v[32:33], v[30:31], v[16:17] op_sel:[0,0] op_sel_hi:[1,0]
    v_pk_fma_f32 v[32:33], v[30:31], v[16:17], v[32:33] op_sel:[1,1,0] op_sel_hi:[0,1,1] neg_lo:[1,0,0]
    v_pk_mul_f32 v[34:35], v[32:33], v[16:17] op_sel:[0,0] op_sel_hi:[1,0]
    v_pk_fma_f32 v[34:35], v[32:33], v[16:17], v[34:35] op_sel:[1,1,0] op_sel_hi:[0,1,1] neg_lo:[1,0,0]
    v_pk_mul_f32 v[36:37], v[34:35], v[16:17] op_sel:[0,0] op_sel_hi:[1,0]
    v_pk_fma_f32 v[36:37], v[34:35], v[16:17], v[36:37] op_sel:[1,1,0] op_sel_hi:[0,1,1] neg_lo:[1,0,0]
    v_pk_mul_f32 v[38:39], v[36:37], v[16:17] op_sel:[0,0] op_sel_hi:[1,0]
    v_pk_fma_f32 v[38:39], v[36:37], v[16:17], v[38:39] op_sel:[1,1,0] op_sel_hi:[0,1,1] neg_lo:[1,0,0]
    v_pk_mul_f32 v[40:41], v[38:39], v[16:17] op_sel:[0,0] op_sel_hi:[1,0]
    v_pk_fma_f32 v[40:41], v[38:39], v[16:17], v[40:41] op_sel:[1,1,0] op_sel_hi:[0,1,1] neg_lo:[1,0,0]
    v_pk_mul_f32 v[42:43], v[40:41], v[16:17] op_sel:[0,0] op_sel_hi:[1,0]
    v_pk_fma_f32 v[42:43], v[40:41], v[16:17], v[42:43] op_sel:[1,1,0] op_sel_hi:[0,1,1] neg_lo:[1,0,0]
    v_pk_mul_f32 v[44:45], v[42:43], v[16:17] op_sel:[0,0] op_sel_hi:[1,0]
    v_pk_fma_f32 v[44:45], v[42:43], v[16:17], v[44:45] op_sel:[1,1,0] op_sel_hi:[0,1,1] neg_lo:[1,0,0]
    v_pk_mul_f32 v[46:47], v[44:45], v[16:17] op_sel:[0,0] op_sel_hi:[1,0]
    v_pk_fma_f32 v[46:47], v[44:45], v[16:17], v[46:47] op_sel:[1,1,0] op_sel_hi:[0,1,1] neg_lo:[1,0,0]
    v_pk_mul_f32 v[48:49], v[46:47], v[16:17] op_sel:[0,0] op_sel_hi:[1,0]
    v_pk_fma_f32 v[48:49], v[46:47], v[16:17], v[48:49] op_sel:[1,1,0] op_sel_hi:[0,1,1] neg_lo:[1,0,0]
    v_pk_mul_f32 v[50:51], v[48:49], v[16:17] op_sel:[0,0] op_sel_hi:[1,0]
    v_pk_fma_f32 v[50:51], v[48:49], v[16:17], v[50:51] op_sel:[1,1,0] op_sel_hi:[0,1,1] neg_lo:[1,0,0]
    v_pk_mul_f32 v[52:53], v[50:51], v[16:17] op_sel:[0,0] op_sel_hi:[1,0]
    v_pk_fma_f32 v[52:53], v[50:51], v[16:17], v[52:53] op_sel:[1,1,0] op_sel_hi:[0,1,1] neg_lo:[1,0,0]
    v_pk_mul_f32 v[54:55], v[52:53], v[16:17] op_sel:[0,0] op_sel_hi:[1,0]
    v_pk_fma_f32 v[54:55], v[52:53], v[16:17], v[54:55] op_sel:[1,1,0] op_sel_hi:[0,1,1] neg_lo:[1,0,0]
    v_pk_mul_f32 v[56:57], v[54:55], v[16:17] op_sel:[0,0] op_sel_hi:[1,0]
    v_pk_fma_f32 v[56:57], v[54:55], v[16:17], v[56:57] op_sel:[1,1,0] op_sel_hi:[0,1,1] neg_lo:[1,0,0]
    v_pk_mul_f32 v[58:59], v[56:57], v[16:17] op_sel:[0,0] op_sel_hi:[1,0]
    v_pk_fma_f32 v[58:59], v[56:57], v[16:17], v[58:59] op_sel:[1,1,0] op_sel_hi:[0,1,1] neg_lo:[1,0,0]
    v_pk_mul_f32 v[60:61], v[58:59], v[16:17] op_sel:[0,0] op_sel_hi:[1,0]
    v_pk_fma_f32 v[60:61], v[58:59], v[16:17], v[60:61] op_sel:[1,1,0] op_sel_hi:[0,1,1] neg_lo:[1,0,0]
    v_pk_mul_f32 v[62:63], v[60:61], v[16:17] op_sel:[0,0] op_sel_hi:[1,0]
    v_pk_fma_f32 v[62:63], v[60:61], v[16:17], v[62:63] op_sel:[1,1,0] op_sel_hi:[0,1,1] neg_lo:[1,0,0]
    v_pk_mul_f32 v[64:65], v[62:63], v[16:17] op_sel:[0,0] op_sel_hi:[1,0]
    v_pk_fma_f32 v[64:65], v[62:63], v[16:17], v[64:65] op_sel:[1,1,0] op_sel_hi:[0,1,1] neg_lo:[1,0,0]
    v_pk_mul_f32 v[66:67], v[64:65], v[16:17] op_sel:[0,0] op_sel_hi:[1,0]
    v_pk_fma_f32 v[66:67], v[64:65], v[16:17], v[66:67] op_sel:[1,1,0] op_sel_hi:[0,1,1] neg_lo:[1,0,0]
    v_pk_mul_f32 v[68:69], v[66:67], v[16:17] op_sel:[0,0] op_sel_hi:[1,0]
    v_pk_fma_f32 v[68:69], v[66:67], v[16:17], v[68:69] op_sel:[1,1,0] op_sel_hi:[0,1,1] neg_lo:[1,0,0]
    v_pk_mul_f32 v[70:71], v[68:69], v[16:17] op_sel:[0,0] op_sel_hi:[1,0]
    v_pk_fma_f32 v[70:71], v[68:69], v[16:17], v[70:71] op_sel:[1,1,0] op_sel_hi:[0,1,1] neg_lo:[1,0,0]
    v_pk_mul_f32 v[72:73], v[70:71], v[16:17] op_sel:[0,0] op_sel_hi:[1,0]
    v_pk_fma_f32 v[72:73], v[70:71], v[16:17], v[72:73] op_sel:[1,1,0] op_sel_hi:[0,1,1] neg_lo:[1,0,0]
    v_pk_mul_f32 v[74:75], v[72:73], v[16:17] op_sel:[0,0] op_sel_hi:[1,0]
    v_pk_fma_f32 v[74:75], v[72:73], v[16:17], v[74:75] op_sel:[1,1,0] op_sel_hi:[0,1,1] neg_lo:[1,0,0]
    v_pk_mul_f32 v[76:77], v[74:75], v[16:17] op_sel:[0,0] op_sel_hi:[1,0]
    v_pk_fma_f32 v[76:77], v[74:75], v[16:17], v[76:77] op_sel:[1,1,0] op_sel_hi:[0,1,1] neg_lo:[1,0,0]
    v_pk_mul_f32 v[78:79], v[76:77], v[16:17] op_sel:[0,0] op_sel_hi:[1,0]
    v_pk_fma_f32 v[78:79], v[76:77], v[16:17], v[78:79] op_sel:[1,1,0] op_sel_hi:[0,1,1] neg_lo:[1,0,0]
    v_pk_mul_f32 v[80:81], v[78:79], v[16:17] op_sel:[0,0] op_sel_hi:[1,0]
    v_pk_fma_f32 v[80:81], v[78:79], v[16:17], v[80:81] op_sel:[1,1,0] op_sel_hi:[0,1,1] neg_lo:[1,0,0]
    v_pk_mul_f32 v[82:83], v[80:81], v[16:17] op_sel:[0,0] op_sel_hi:[1,0]
    v_pk_fma_f32 v[82:83], v[80:81], v[16:17], v[82:83] op_sel:[1,1,0] op_sel_hi:[0,1,1] neg_lo:[1,0,0]
    v_cvt_pk_bf16_f32 v88, v20, v22
    v_cvt_pk_bf16_f32 v89, v24, v26
    v_cvt_pk_bf16_f32 v90, v28, v30
    v_cvt_pk_bf16_f32 v91, v32, v34
    ds_write_b128 v8, v[88:91]
    v_cvt_pk_bf16_f32 v92, v36, v38
    v_cvt_pk_bf16_f32 v93, v40, v42
    v_cvt_pk_bf16_f32 v94, v44, v46
    v_cvt_pk_bf16_f32 v95, v48, v50
    v_xor_b32_e64 v96, 16, v8
    ds_write_b128 v96, v[92:95]
    v_cvt_pk_bf16_f32 v88, v52, v54
    v_cvt_pk_bf16_f32 v89, v56, v58
    v_cvt_pk_bf16_f32 v90, v60, v62
    v_cvt_pk_bf16_f32 v91, v64, v66
    v_xor_b32_e64 v97, 32, v8
    ds_write_b128 v97, v[88:91]
    v_cvt_pk_bf16_f32 v92, v68, v70
    v_cvt_pk_bf16_f32 v93, v72, v74
    v_cvt_pk_bf16_f32 v94, v76, v78
    v_cvt_pk_bf16_f32 v95, v80, v82
    v_xor_b32_e64 v96, 48, v8
    ds_write_b128 v96, v[92:95]
    v_cvt_pk_bf16_f32 v88, v21, v23
    v_cvt_pk_bf16_f32 v89, v25, v27
    v_cvt_pk_bf16_f32 v90, v29, v31
    v_cvt_pk_bf16_f32 v91, v33, v35
    v_xor_b32_e64 v97, 64, v8
    ds_write_b128 v97, v[88:91]
    v_cvt_pk_bf16_f32 v92, v37, v39
    v_cvt_pk_bf16_f32 v93, v41, v43
    v_cvt_pk_bf16_f32 v94, v45, v47
    v_cvt_pk_bf16_f32 v95, v49, v51
    v_xor_b32 v96, 80, v8
    ds_write_b128 v96, v[92:95]
    v_cvt_pk_bf16_f32 v88, v53, v55
    v_cvt_pk_bf16_f32 v89, v57, v59
    v_cvt_pk_bf16_f32 v90, v61, v63
    v_cvt_pk_bf16_f32 v91, v65, v67
    v_xor_b32 v97, 96, v8
    ds_write_b128 v97, v[88:91]
    v_cvt_pk_bf16_f32 v92, v69, v71
    v_cvt_pk_bf16_f32 v93, v73, v75
    v_cvt_pk_bf16_f32 v94, v77, v79
    v_cvt_pk_bf16_f32 v95, v81, v83
    v_xor_b32 v96, 112, v8
    ds_write_b128 v96, v[92:95]
L_kg_join:
    v_lshrrev_b32 v2, 5, v0
    v_bfe_u32 v3, v0, 3, 1
    v_lshl_add_u32 v2, v2, 2, v3
    v_bfe_u32 v3, v0, 2, 1
    v_bfe_u32 v4, v0, 4, 1
    v_lshlrev_b32 v4, 1, v4
    v_lshl_add_u32 v3, v3, 2, v4
    v_bfe_u32 v4, v0, 1, 1
    v_add_u32 v3, v3, v4
    v_and_b32 v4, 1, v0
    v_lshlrev_b32 v4, 3, v4
    v_xor_b32 v5, v3, v2
    v_lshl_add_u32 v5, v5, 4, v4
    v_lshl_add_u32 v6, v2, 7, v5
    v_add_u32 v2, 2, v2
    v_xor_b32 v5, v3, v2
    v_lshl_add_u32 v5, v5, 4, v4
    v_lshl_add_u32 v7, v2, 7, v5
    v_lshlrev_b32 v1, 4, v0
    s_waitcnt lgkmcnt(0)
    s_barrier
    s_cmp_lg_u32 s15, 0
    s_cbranch_scc1 L_tok7
    s_mov_b32 s14, 200000
    v_mov_b32 v106, 0
L_tag7:
    global_load_dword v107, v106, s[42:43] sc1
    s_sub_u32 s14, s14, 1
    s_waitcnt vmcnt(0)
    v_readfirstlane_b32 s15, v107
    s_nop 1
    s_cmp_lg_u32 s15, 0
    s_cbranch_scc1 L_tok7
    s_cmp_lg_u32 s14, 0
    s_cbranch_scc1 L_tag7
L_tok7:
    s_setprio 2
    s_cmp_lg_u32 s3, 0
    s_cbranch_scc1 L_a_uload
    s_nop 0
    ds_read_b64_tr_b16 v[32:33], v6 offset:0
    ds_read_b64_tr_b16 v[34:35], v7 offset:0
    ds_read_b64_tr_b16 v[36:37], v6 offset:16384
    ds_read_b64_tr_b16 v[38:39], v7 offset:16384
    ds_read_b64_tr_b16 v[40:41], v6 offset:1024
    ds_read_b64_tr_b16 v[42:43], v7 offset:1024
    ds_read_b64_tr_b16 v[44:45], v6 offset:17408
    ds_read_b64_tr_b16 v[46:47], v7 offset:17408
    ds_read_b64_tr_b16 v[48:49], v6 offset:2048
    ds_read_b64_tr_b16 v[50:51], v7 offset:2048
    ds_read_b64_tr_b16 v[52:53], v6 offset:18432
    ds_read_b64_tr_b16 v[54:55], v7 offset:18432
    v_and_b32 v8, 31, v0
    v_lshlrev_b32 v8, 4, v8
    v_sub_u32 v8, 1008, v8
    v_lshrrev_b32 v9, 5, v0
    v_lshlrev_b32 v9, 9, v9
    v_sub_u32 v10, v8, v9
    v_add_u32 v10, 2048, v10
    v_sub_u32 v11, v8, v9
    v_sub_u32 v11, v11, v9
    v_add_u32 v11, 512, v11
    v_and_b32 v12, 1, v0
    v_cmp_eq_u32 s[4:5], 0, v12
    v_cmp_eq_u32 vcc, 0, v0
    v_mov_b32 v13, s71
    s_nop 0
    v_cndmask_b32 v13, 0, v13, vcc
    v_add_u32 v64, 8332, v10
    v_add_u32 v65, 8332, v11
    v_add_u32 v66, 4172, v10
    v_add_u32 v67, 4172, v11
    v_add_u32 v68, 1024, v64
    v_add_u32 v69, 1024, v66
    v_lshrrev_b32 v2, 4, v0
    v_mul_u32_u24 v2, 4160, v2
    v_and_b32 v3, 15, v0
    v_lshl_add_u32 v2, v3, 2, v2
    s_waitcnt lgkmcnt(8)
    v_mfma_f32_32x32x16_bf16 v[16:31], v[32:35], v[36:39], 0
    ds_read_b64_tr_b16 v[56:57], v6 offset:3072
    ds_read_b64_tr_b16 v[58:59], v7 offset:3072
    ds_read_b64_tr_b16 v[60:61], v6 offset:19456
    ds_read_b64_tr_b16 v[62:63], v7 offset:19456
    s_waitcnt lgkmcnt(8)
    v_mfma_f32_32x32x16_bf16 v[16:31], v[40:43], v[44:47], v[16:31]
    ds_read_b64_tr_b16 v[32:33], v6 offset:4096
    ds_read_b64_tr_b16 v[34:35], v7 offset:4096
    ds_read_b64_tr_b16 v[36:37], v6 offset:20480
    ds_read_b64_tr_b16 v[38:39], v7 offset:20480
    s_waitcnt lgkmcnt(8)
    v_mfma_f32_32x32x16_bf16 v[16:31], v[48:51], v[52:55], v[16:31]
    ds_read_b64_tr_b16 v[40:41], v6 offset:5120
    ds_read_b64_tr_b16 v[42:43], v7 offset:5120
    ds_read_b64_tr_b16 v[44:45], v6 offset:21504
    ds_read_b64_tr_b16 v[46:47], v7 offset:21504
    s_waitcnt lgkmcnt(8)
    v_mfma_f32_32x32x16_bf16 v[16:31], v[56:59], v[60:63], v[16:31]
    ds_read_b64_tr_b16 v[48:49], v6 offset:6144
    ds_read_b64_tr_b16 v[50:51], v7 offset:6144
    ds_read_b64_tr_b16 v[52:53], v6 offset:22528
    ds_read_b64_tr_b16 v[54:55], v7 offset:22528
    s_waitcnt lgkmcnt(8)
    v_mfma_f32_32x32x16_bf16 v[16:31], v[32:35], v[36:39], v[16:31]
    ds_read_b64_tr_b16 v[56:57], v6 offset:7168
    ds_read_b64_tr_b16 v[58:59], v7 offset:7168
    ds_read_b64_tr_b16 v[60:61], v6 offset:23552
    ds_read_b64_tr_b16 v[62:63], v7 offset:23552
    s_waitcnt lgkmcnt(8)
    v_mfma_f32_32x32x16_bf16 v[16:31], v[40:43], v[44:47], v[16:31]
    ds_read_b64_tr_b16 v[32:33], v6 offset:8192
    ds_read_b64_tr_b16 v[34:35], v7 offset:8192
    ds_read_b64_tr_b16 v[36:37], v6 offset:24576
    ds_read_b64_tr_b16 v[38:39], v7 offset:24576
    s_waitcnt lgkmcnt(8)
    v_mfma_f32_32x32x16_bf16 v[16:31], v[48:51], v[52:55], v[16:31]
    ds_read_b64_tr_b16 v[40:41], v6 offset:9216
    ds_read_b64_tr_b16 v[42:43], v7 offset:9216
    ds_read_b64_tr_b16 v[44:45], v6 offset:25600
    ds_read_b64_tr_b16 v[46:47], v7 offset:25600
    s_waitcnt lgkmcnt(8)
    v_mfma_f32_32x32x16_bf16 v[16:31], v[56:59], v[60:63], v[16:31]
    ds_read_b64_tr_b16 v[48:49], v6 offset:10240
    ds_read_b64_tr_b16 v[50:51], v7 offset:10240
    ds_read_b64_tr_b16 v[52:53], v6 offset:26624
    ds_read_b64_tr_b16 v[54:55], v7 offset:26624
    s_waitcnt lgkmcnt(8)
    v_mfma_f32_32x32x16_bf16 v[16:31], v[32:35], v[36:39], v[16:31]
    ds_read_b64_tr_b16 v[56:57], v6 offset:11264
    ds_read_b64_tr_b16 v[58:59], v7 offset:11264
    ds_read_b64_tr_b16 v[60:61], v6 offset:27648
    ds_read_b64_tr_b16 v[62:63], v7 offset:27648
    s_waitcnt lgkmcnt(8)
    v_mfma_f32_32x32x16_bf16 v[16:31], v[40:43], v[44:47], v[16:31]
    ds_read_b64_tr_b16 v[32:33], v6 offset:12288
    ds_read_b64_tr_b16 v[34:35], v7 offset:12288
    ds_read_b64_tr_b16 v[36:37], v6 offset:28672
    ds_read_b64_tr_b16 v[38:39], v7 offset:28672
    s_waitcnt lgkmcnt(8)
    v_mfma_f32_32x32x16_bf16 v[16:31], v[48:51], v[52:55], v[16:31]
    ds_read_b64_tr_b16 v[40:41], v6 offset:13312
    ds_read_b64_tr_b16 v[42:43], v7 offset:13312
    ds_read_b64_tr_b16 v[44:45], v6 offset:29696
    ds_read_b64_tr_b16 v[46:47], v7 offset:29696
    s_waitcnt lgkmcnt(8)
    v_mfma_f32_32x32x16_bf16 v[16:31], v[56:59], v[60:63], v[16:31]
    ds_read_b64_tr_b16 v[48:49], v6 offset:14336
    ds_read_b64_tr_b16 v[50:51], v7 offset:14336
    ds_read_b64_tr_b16 v[52:53], v6 offset:30720
    ds_read_b64_tr_b16 v[54:55], v7 offset:30720
    s_waitcnt lgkmcnt(8)
    v_mfma_f32_32x32x16_bf16 v[16:31], v[32:35], v[36:39], v[16:31]
    ds_read_b64_tr_b16 v[56:57], v6 offset:15360
    ds_read_b64_tr_b16 v[58:59], v7 offset:15360
    ds_read_b64_tr_b16 v[60:61], v6 offset:31744
    ds_read_b64_tr_b16 v[62:63], v7 offset:31744
    s_waitcnt lgkmcnt(8)
    v_mfma_f32_32x32x16_bf16 v[16:31], v[40:43], v[44:47], v[16:31]
    s_waitcnt lgkmcnt(4)
    v_mfma_f32_32x32x16_bf16 v[16:31], v[48:51], v[52:55], v[16:31]
    s_waitcnt lgkmcnt(0)
    v_mfma_f32_32x32x16_bf16 v[16:31], v[56:59], v[60:63], v[16:31]
    s_nop 11
    v_add_f32 v16, v16, v13
    v_cndmask_b32 v14, v29, v28, s[4:5]
    v_cndmask_b32 v15, v31, v30, s[4:5]
    v_cvt_pk_bf16_f32 v32, v23, v22
    v_cvt_pk_bf16_f32 v33, v21, v20
    v_cvt_pk_bf16_f32 v34, v19, v18
    v_cvt_pk_bf16_f32 v35, v17, v16
    ds_write2_b32 v68, v32, v33 offset0:0 offset1:1
    ds_write2_b32 v68, v34, v35 offset0:2 offset1:3
    ds_write_b128 v10, v[32:35] offset:1040
    v_cvt_pk_bf16_f32 v36, v24, v23
    v_cvt_pk_bf16_f32 v37, v22, v21
    v_cvt_pk_bf16_f32 v38, v20, v19
    v_cvt_pk_bf16_f32 v39, v18, v17
    ds_write2_b32 v69, v36, v37 offset0:0 offset1:1
    ds_write2_b32 v69, v38, v39 offset0:2 offset1:3
    ds_write_b64 v10, v[36:37] offset:13512
    ds_write_b64 v10, v[38:39] offset:13520
    v_cvt_pk_bf16_f32 v40, v27, v27
    v_cvt_pk_bf16_f32 v41, v26, v26
    v_cvt_pk_bf16_f32 v42, v26, v25
    v_cvt_pk_bf16_f32 v43, v25, v25
    ds_write2_b32 v64, v40, v41 offset0:0 offset1:1
    ds_write2_b32 v64, v42, v43 offset0:2 offset1:3
    ds_write_b128 v10, v[40:43] offset:16
    v_cvt_pk_bf16_f32 v44, v27, v27
    v_cvt_pk_bf16_f32 v45, v27, v26
    v_cvt_pk_bf16_f32 v46, v26, v26
    v_cvt_pk_bf16_f32 v47, v25, v25
    ds_write2_b32 v66, v44, v45 offset0:0 offset1:1
    ds_write2_b32 v66, v46, v47 offset0:2 offset1:3
    ds_write_b64 v10, v[44:45] offset:12488
    ds_write_b64 v10, v[46:47] offset:12496
    v_cvt_pk_bf16_f32 v48, v29, v29
    v_cvt_pk_bf16_f32 v49, v29, v14
    v_cvt_pk_bf16_f32 v50, v28, v28
    v_cvt_pk_bf16_f32 v51, v28, v28
    ds_write2_b32 v65, v48, v49 offset0:128 offset1:129
    ds_write2_b32 v65, v50, v51 offset0:130 offset1:131
    ds_write_b128 v11, v[48:51] offset:528
    v_cvt_pk_bf16_f32 v52, v29, v29
    v_cvt_pk_bf16_f32 v53, v29, v29
    v_cvt_pk_bf16_f32 v54, v14, v28
    v_cvt_pk_bf16_f32 v55, v28, v28
    ds_write2_b32 v67, v52, v53 offset0:128 offset1:129
    ds_write2_b32 v67, v54, v55 offset0:130 offset1:131
    ds_write_b64 v11, v[52:53] offset:13000
    ds_write_b64 v11, v[54:55] offset:13008
    v_cvt_pk_bf16_f32 v56, v31, v31
    v_cvt_pk_bf16_f32 v57, v31, v15
    v_cvt_pk_bf16_f32 v58, v30, v30
    v_cvt_pk_bf16_f32 v59, v30, v30
    ds_write2_b32 v65, v56, v57 offset0:0 offset1:1
    ds_write2_b32 v65, v58, v59 offset0:2 offset1:3
    ds_write_b128 v11, v[56:59] offset:16
    v_cvt_pk_bf16_f32 v60, v31, v31
    v_cvt_pk_bf16_f32 v61, v31, v31
    v_cvt_pk_bf16_f32 v62, v15, v30
    v_cvt_pk_bf16_f32 v63, v30, v30
    ds_write2_b32 v67, v60, v61 offset0:0 offset1:1
    ds_write2_b32 v67, v62, v63 offset0:2 offset1:3
    ds_write_b64 v11, v[60:61] offset:12488
    ds_write_b64 v11, v[62:63] offset:12496
    v_cvt_pk_bf16_f32 v4, v16, 0
    s_nop 0
    v_readfirstlane_b32 s4, v4
    v_mov_b32 v4, 0
    s_nop 0
    v_writelane_b32 v4, s4, 17
    v_writelane_b32 v4, s4, 48
    s_mov_b32 exec_lo, 0xfffefffc
    s_mov_b32 exec_hi, 0xfffffffe
    ds_write_b32 v2, v4 offset:4104
    s_mov_b64 exec, -1
    s_branch L_a_conv
L_a_uload:
    v_mov_b32 v2, 0
    v_mov_b32 v3, 0
    v_lshlrev_b32 v4, 3, v0
    ds_write_b64 v4, v[2:3] offset:33280
    s_lshl_b32 s4, s3, 6
    s_sub_u32 s4, s4, 64
    v_add_u32 v4, s4, v0
    v_add_u32 v5, 192, v4
    v_and_b32 v6, 3, v0
    v_add_u32 v7, 272, v6
    v_min_u32 v5, v7, v5
    v_lshlrev_b32 v2, 4, v4
    v_lshlrev_b32 v3, 4, v5
    v_and_b32 v4, -4, v4
    v_and_b32 v5, -4, v5
    v_sub_u32 v4, v2, v4
    v_sub_u32 v5, v3, v5
    s_mov_b32 s14, 200000
L_poll8:
    s_sleep 10
    buffer_load_dwordx4 v[16:19], v2, s[52:55], s67 offen sc1
    buffer_load_dwordx4 v[20:23], v3, s[52:55], s67 offen sc1
    s_sub_u32 s14, s14, 1
    s_waitcnt vmcnt(0)
    v_xor_b32 v6, s15, v19
    v_bitop3_b32 v6, v23, v6, s15 bitop3:0xde
    s_mov_b32 exec_lo, 0x88888888
    s_mov_b32 exec_hi, 0x88888888
    v_cmp_ne_u32 vcc, 0, v6
    s_mov_b64 exec, -1
    s_cbranch_vccz L_pok8
    s_cmp_lg_u32 s14, 0
    s_cbranch_scc1 L_poll8
L_pok8:
    v_add_u32 v4, 33792, v4
    v_add_u32 v5, 33792, v5
    ds_write2_b32 v4, v16, v17 offset0:0 offset1:1
    ds_write_b32 v4, v18 offset:8
    ds_write2_b32 v5, v20, v21 offset0:0 offset1:1
    ds_write_b32 v5, v22 offset:8
    s_mov_b32 exec_lo, 0x77777777
    s_mov_b32 exec_hi, 0x77777777
    ds_write_b32 v4, v19 offset:12
    ds_write_b32 v5, v23 offset:12
    s_mov_b64 exec, -1
L_a_conv:
    s_setprio 0
    v_and_b32 v2, 3, v0
    v_sub_u32 v2, 3, v2
    v_mul_u32_u24 v2, 4160, v2
    v_lshrrev_b32 v3, 4, v0
    v_lshl_add_u32 v2, v3, 4, v2
    v_bfe_u32 v4, v0, 2, 2
    v_lshlrev_b32 v4, 3, v4
    v_sub_u32 v2, v2, v4
    s_lshl_b32 s12, s3, 6
    s_sub_u32 s13, 232, s12
    v_add_u32 v2, s13, v2
    v_and_b32 v4, 15, v0
    v_lshlrev_b32 v5, 5, v4
    v_lshl_add_u32 v5, v3, 4, v5
    s_sub_u32 s13, 33504, s12
    v_add_u32 v3, s13, v5
    v_add_u32 v6, s68, v1
    s_and_b32 s12, s3, 1
    s_lshl_b32 s12, s12, 13
    s_cmp_lt_u32 s3, 2
    s_cselect_b32 s13, 16768, 0
    s_add_u32 s12, s12, s13
    v_lshrrev_b32 v7, 5, v0
    v_lshlrev_b32 v7, 12, v7
    v_bfe_u32 v4, v0, 1, 4
    v_lshl_add_u32 v7, v4, 4, v7
    v_and_b32 v4, 1, v0
    v_lshl_add_u32 v7, v4, 9, v7
    v_add_u32 v7, s12, v7
    s_waitcnt lgkmcnt(0)
    s_barrier
    s_nop 0
    ds_read_b64 v[112:113], v2 offset:1536
    ds_read_b64 v[114:115], v2 offset:1544
    ds_read_b128 v[16:19], v3 offset:0
    ds_read_b128 v[24:27], v3 offset:512
    ds_read_b128 v[32:35], v3 offset:1024
    ds_read_b128 v[40:43], v3 offset:1536
    ds_read_b64 v[116:117], v2 offset:1792
    ds_read_b64 v[118:119], v2 offset:1800
    ds_read_b128 v[20:23], v3 offset:256
    ds_read_b128 v[28:31], v3 offset:768
    ds_read_b128 v[36:39], v3 offset:1280
    ds_read_b128 v[44:47], v3 offset:1792
    ds_read_b64 v[120:121], v2 offset:3584
    ds_read_b64 v[122:123], v2 offset:3592
    s_waitcnt lgkmcnt(11)
    v_mfma_f32_16x16x32_bf16 v[96:99], v[112:115], v[16:19], 0
    ds_read_b128 v[48:51], v3 offset:2048
    s_waitcnt lgkmcnt(11)
    v_mfma_f32_16x16x32_bf16 v[100:103], v[112:115], v[24:27], 0
    ds_read_b128 v[56:59], v3 offset:2560
    s_waitcnt lgkmcnt(11)
    v_mfma_f32_16x16x32_bf16 v[104:107], v[112:115], v[32:35], 0
    ds_read_b128 v[64:67], v3 offset:3072
    s_waitcnt lgkmcnt(11)
    v_mfma_f32_16x16x32_bf16 v[108:111], v[112:115], v[40:43], 0
    ds_read_b128 v[72:75], v3 offset:3584
    ds_read_b64 v[124:125], v2 offset:3840
    ds_read_b64 v[126:127], v2 offset:3848
    s_waitcnt lgkmcnt(11)
    v_mfma_f32_16x16x32_bf16 v[96:99], v[116:119], v[20:23], v[96:99]
    s_waitcnt lgkmcnt(10)
    v_mfma_f32_16x16x32_bf16 v[100:103], v[116:119], v[28:31], v[100:103]
    s_waitcnt lgkmcnt(9)
    v_mfma_f32_16x16x32_bf16 v[104:107], v[116:119], v[36:39], v[104:107]
    s_waitcnt lgkmcnt(8)
    v_mfma_f32_16x16x32_bf16 v[108:111], v[116:119], v[44:47], v[108:111]
    s_waitcnt lgkmcnt(6)
    s_nop 0
    v_mfma_f32_16x16x32_bf16 v[80:83], v[120:123], v[16:19], 0
    ds_read_b128 v[52:55], v3 offset:2304
    v_mfma_f32_16x16x32_bf16 v[84:87], v[120:123], v[24:27], 0
    ds_read_b128 v[60:63], v3 offset:2816
    v_mfma_f32_16x16x32_bf16 v[88:91], v[120:123], v[32:35], 0
    ds_read_b128 v[68:71], v3 offset:3328
    v_mfma_f32_16x16x32_bf16 v[92:95], v[120:123], v[40:43], 0
    ds_read_b128 v[76:79], v3 offset:3840
    ds_read_b64 v[8:9], v2 offset:0
    ds_read_b64 v[10:11], v2 offset:8
    ds_read_b64 v[12:13], v2 offset:3328
    ds_read_b64 v[14:15], v2 offset:3336
    s_waitcnt lgkmcnt(13)
    v_mfma_f32_16x16x32_bf16 v[96:99], v[120:123], v[48:51], v[96:99]
    s_waitcnt lgkmcnt(12)
    v_mfma_f32_16x16x32_bf16 v[100:103], v[120:123], v[56:59], v[100:103]
    s_waitcnt lgkmcnt(11)
    v_mfma_f32_16x16x32_bf16 v[104:107], v[120:123], v[64:67], v[104:107]
    s_waitcnt lgkmcnt(10)
    v_mfma_f32_16x16x32_bf16 v[108:111], v[120:123], v[72:75], v[108:111]
    s_waitcnt lgkmcnt(8)
    v_mfma_f32_16x16x32_bf16 v[80:83], v[124:127], v[20:23], v[80:83]
    ds_read_b64 v[112:113], v2 offset:256
    ds_read_b64 v[114:115], v2 offset:264
    ds_read_b64 v[116:117], v2 offset:3072
    ds_read_b64 v[118:119], v2 offset:3080
    v_mfma_f32_16x16x32_bf16 v[84:87], v[124:127], v[28:31], v[84:87]
    v_mfma_f32_16x16x32_bf16 v[88:91], v[124:127], v[36:39], v[88:91]
    v_mfma_f32_16x16x32_bf16 v[92:95], v[124:127], v[44:47], v[92:95]
    s_waitcnt lgkmcnt(11)
    v_mfma_f32_16x16x32_bf16 v[96:99], v[124:127], v[52:55], v[96:99]
    s_waitcnt lgkmcnt(10)
    v_mfma_f32_16x16x32_bf16 v[100:103], v[124:127], v[60:63], v[100:103]
    s_waitcnt lgkmcnt(9)
    v_mfma_f32_16x16x32_bf16 v[104:107], v[124:127], v[68:71], v[104:107]
    s_waitcnt lgkmcnt(8)
    v_mfma_f32_16x16x32_bf16 v[108:111], v[124:127], v[76:79], v[108:111]
    s_waitcnt lgkmcnt(6)
    v_mfma_f32_16x16x32_bf16 v[108:111], v[8:11], v[16:19], v[108:111]
    ds_read_b64 v[120:121], v2 offset:512
    ds_read_b64 v[122:123], v2 offset:520
    ds_read_b64 v[124:125], v2 offset:2816
    ds_read_b64 v[126:127], v2 offset:2824
    s_waitcnt lgkmcnt(8)
    v_mfma_f32_16x16x32_bf16 v[84:87], v[12:15], v[20:23], v[84:87]
    v_mfma_f32_16x16x32_bf16 v[88:91], v[12:15], v[28:31], v[88:91]
    v_mfma_f32_16x16x32_bf16 v[92:95], v[12:15], v[36:39], v[92:95]
    v_mfma_f32_16x16x32_bf16 v[96:99], v[12:15], v[44:47], v[96:99]
    v_mfma_f32_16x16x32_bf16 v[100:103], v[12:15], v[52:55], v[100:103]
    v_mfma_f32_16x16x32_bf16 v[104:107], v[12:15], v[60:63], v[104:107]
    v_mfma_f32_16x16x32_bf16 v[108:111], v[12:15], v[68:71], v[108:111]
    ds_write_b128 v6, v[80:83] offset:16768
    s_waitcnt lgkmcnt(7)
    v_mfma_f32_16x16x32_bf16 v[108:111], v[112:115], v[20:23], v[108:111]
    ds_read_b64 v[8:9], v2 offset:768
    ds_read_b64 v[10:11], v2 offset:776
    ds_read_b64 v[12:13], v2 offset:2560
    ds_read_b64 v[14:15], v2 offset:2568
    s_waitcnt lgkmcnt(9)
    v_mfma_f32_16x16x32_bf16 v[84:87], v[116:119], v[16:19], v[84:87]
    v_mfma_f32_16x16x32_bf16 v[88:91], v[116:119], v[24:27], v[88:91]
    v_mfma_f32_16x16x32_bf16 v[92:95], v[116:119], v[32:35], v[92:95]
    v_mfma_f32_16x16x32_bf16 v[96:99], v[116:119], v[40:43], v[96:99]
    v_mfma_f32_16x16x32_bf16 v[100:103], v[116:119], v[48:51], v[100:103]
    v_mfma_f32_16x16x32_bf16 v[104:107], v[116:119], v[56:59], v[104:107]
    v_mfma_f32_16x16x32_bf16 v[108:111], v[116:119], v[64:67], v[108:111]
    s_waitcnt lgkmcnt(7)
    v_mfma_f32_16x16x32_bf16 v[104:107], v[120:123], v[16:19], v[104:107]
    ds_read_b64 v[112:113], v2 offset:1024
    ds_read_b64 v[114:115], v2 offset:1032
    ds_read_b64 v[116:117], v2 offset:2304
    ds_read_b64 v[118:119], v2 offset:2312
    v_mfma_f32_16x16x32_bf16 v[108:111], v[120:123], v[24:27], v[108:111]
    s_waitcnt lgkmcnt(9)
    v_mfma_f32_16x16x32_bf16 v[88:91], v[124:127], v[20:23], v[88:91]
    v_mfma_f32_16x16x32_bf16 v[92:95], v[124:127], v[28:31], v[92:95]
    v_mfma_f32_16x16x32_bf16 v[96:99], v[124:127], v[36:39], v[96:99]
    v_mfma_f32_16x16x32_bf16 v[100:103], v[124:127], v[44:47], v[100:103]
    v_mfma_f32_16x16x32_bf16 v[104:107], v[124:127], v[52:55], v[104:107]
    v_mfma_f32_16x16x32_bf16 v[108:111], v[124:127], v[60:63], v[108:111]
    ds_write_b128 v6, v[84:87] offset:20864
    s_waitcnt lgkmcnt(7)
    v_mfma_f32_16x16x32_bf16 v[104:107], v[8:11], v[20:23], v[104:107]
    ds_read_b64 v[120:121], v2 offset:1280
    ds_read_b64 v[122:123], v2 offset:1288
    ds_read_b64 v[124:125], v2 offset:2048
    ds_read_b64 v[126:127], v2 offset:2056
    v_mfma_f32_16x16x32_bf16 v[108:111], v[8:11], v[28:31], v[108:111]
    s_waitcnt lgkmcnt(9)
    v_mfma_f32_16x16x32_bf16 v[88:91], v[12:15], v[16:19], v[88:91]
    v_mfma_f32_16x16x32_bf16 v[92:95], v[12:15], v[24:27], v[92:95]
    v_mfma_f32_16x16x32_bf16 v[96:99], v[12:15], v[32:35], v[96:99]
    v_mfma_f32_16x16x32_bf16 v[100:103], v[12:15], v[40:43], v[100:103]
    v_mfma_f32_16x16x32_bf16 v[104:107], v[12:15], v[48:51], v[104:107]
    v_mfma_f32_16x16x32_bf16 v[108:111], v[12:15], v[56:59], v[108:111]
    s_waitcnt lgkmcnt(7)
    v_mfma_f32_16x16x32_bf16 v[100:103], v[112:115], v[16:19], v[100:103]
    v_mfma_f32_16x16x32_bf16 v[104:107], v[112:115], v[24:27], v[104:107]
    v_mfma_f32_16x16x32_bf16 v[108:111], v[112:115], v[32:35], v[108:111]
    s_waitcnt lgkmcnt(5)
    v_mfma_f32_16x16x32_bf16 v[92:95], v[116:119], v[20:23], v[92:95]
    v_mfma_f32_16x16x32_bf16 v[96:99], v[116:119], v[28:31], v[96:99]
    v_mfma_f32_16x16x32_bf16 v[100:103], v[116:119], v[36:39], v[100:103]
    v_mfma_f32_16x16x32_bf16 v[104:107], v[116:119], v[44:47], v[104:107]
    v_mfma_f32_16x16x32_bf16 v[108:111], v[116:119], v[52:55], v[108:111]
    ds_write_b128 v6, v[88:91] offset:24960
    s_waitcnt lgkmcnt(3)
    v_mfma_f32_16x16x32_bf16 v[100:103], v[120:123], v[20:23], v[100:103]
    v_mfma_f32_16x16x32_bf16 v[104:107], v[120:123], v[28:31], v[104:107]
    v_mfma_f32_16x16x32_bf16 v[108:111], v[120:123], v[36:39], v[108:111]
    s_waitcnt lgkmcnt(1)
    v_mfma_f32_16x16x32_bf16 v[92:95], v[124:127], v[16:19], v[92:95]
    v_mfma_f32_16x16x32_bf16 v[96:99], v[124:127], v[24:27], v[96:99]
    v_mfma_f32_16x16x32_bf16 v[100:103], v[124:127], v[32:35], v[100:103]
    v_mfma_f32_16x16x32_bf16 v[104:107], v[124:127], v[40:43], v[104:107]
    v_mfma_f32_16x16x32_bf16 v[108:111], v[124:127], v[48:51], v[108:111]
    s_barrier
    s_setprio 1
    s_nop 1
    ds_write_b128 v6, v[92:95] offset:29056
    ds_write_b128 v6, v[96:99] offset:0
    ds_write_b128 v6, v[100:103] offset:4096
    ds_write_b128 v6, v[104:107] offset:8192
    ds_write_b128 v6, v[108:111] offset:12288
    s_waitcnt lgkmcnt(0)
    s_barrier
    ds_read_b128 v[16:19], v7 offset:0
    ds_read_b128 v[20:23], v7 offset:1024
    ds_read_b128 v[24:27], v7 offset:2048
    ds_read_b128 v[28:31], v7 offset:3072
    ds_read_b128 v[32:35], v7 offset:256
    ds_read_b128 v[36:39], v7 offset:1280
    ds_read_b128 v[40:43], v7 offset:2304
    ds_read_b128 v[44:47], v7 offset:3328
    s_waitcnt lgkmcnt(4)
    v_add_f32 v16, v16, v20
    v_add_f32 v24, v24, v28
    v_add_f32 v17, v17, v21
    v_add_f32 v25, v25, v29
    v_add_f32 v18, v18, v22
    v_add_f32 v26, v26, v30
    v_add_f32 v19, v19, v23
    v_add_f32 v27, v27, v31
    v_add_f32 v16, v16, v24
    v_add_f32 v17, v17, v25
    v_add_f32 v18, v18, v26
    v_add_f32 v19, v19, v27
    v_cvt_pk_bf16_f32 v12, v16, v17
    v_cvt_pk_bf16_f32 v13, v18, v19
    s_waitcnt lgkmcnt(0)
    v_add_f32 v32, v32, v36
    v_add_f32 v40, v40, v44
    v_add_f32 v33, v33, v37
    v_add_f32 v41, v41, v45
    v_add_f32 v34, v34, v38
    v_add_f32 v42, v42, v46
    v_add_f32 v35, v35, v39
    v_add_f32 v43, v43, v47
    v_add_f32 v32, v32, v40
    v_add_f32 v33, v33, v41
    v_add_f32 v34, v34, v42
    v_add_f32 v35, v35, v43
    v_cvt_pk_bf16_f32 v14, v32, v33
    v_cvt_pk_bf16_f32 v15, v34, v35
    ds_write_b128 v6, v[12:15] offset:33280
    s_lshl_b32 s4, s3, 6
    v_add_u32 v4, s4, v0
    v_and_b32 v5, -4, v4
    v_sub_u32 v5, v6, v5
    v_add_u32 v5, 33280, v5
    v_add_u32 v8, 3840, v5
    s_add_u32 s4, s67, 4096
    s_waitcnt lgkmcnt(0)
    s_barrier
    ds_read2_b32 v[16:17], v5 offset0:0 offset1:1
    ds_read2_b32 v[18:19], v5 offset0:2 offset1:3
    ds_read2_b32 v[20:21], v8 offset0:0 offset1:1
    ds_read2_b32 v[22:23], v8 offset0:2 offset1:3
    s_mov_b32 exec_lo, 0x88888888
    s_mov_b32 exec_hi, 0x88888888
    s_waitcnt lgkmcnt(0)
    v_mov_b32 v19, s15
    v_mov_b32 v23, s15
    s_mov_b64 exec, -1
    buffer_store_dwordx4 v[16:19], v6, s[56:59], s67 offen sc1
    s_cmp_lg_u32 s3, 0
    s_cbranch_scc1 L_a_y1
    s_mov_b64 exec, 0xffffff
    buffer_store_dwordx4 v[20:23], v6, s[56:59], s4 offen sc1
    s_mov_b64 exec, -1
L_a_y1:
    s_add_u32 s64, s61, 4294967145
    s_sub_u32 s5, s61, 151
    s_cmp_lt_u32 s5, 105
    s_cbranch_scc1 L_task9
    s_add_u32 s64, s61, 4294967064
    s_sub_u32 s5, s61, 337
    s_cmp_lt_u32 s5, 175
    s_cbranch_scc1 L_task9
    s_add_u32 s64, s61, 4294967064
    s_sub_u32 s5, s61, 512
    s_cmp_ge_u32 s5, 35
    s_cbranch_scc1 L_a_end
L_task9:
    s_mul_i32 s5, s64, 1873
    s_lshr_b32 s5, s5, 16
    s_mul_i32 s65, s5, 35
    s_sub_u32 s65, s64, s65
    s_mov_b32 s64, s5
    s_mov_b32 s72, s40
    s_mov_b32 s73, s41
    s_mov_b32 s74, 4718592
    s_mov_b32 s75, 0x20000
    v_lshrrev_b32 v98, 3, v0
    v_and_b32 v99, 7, v0
    v_mul_u32_u24 v2, 4480, v98
    v_lshl_add_u32 v2, v99, 4, v2
    s_lshl_b32 s66, s64, 2
    s_add_u32 s66, s66, s3
    s_mul_i32 s66, s66, 71680
    s_lshl_b32 s5, s65, 7
    s_add_u32 s66, s66, s5
    s_add_u32 s5, s66, 35840
    v_mul_u32_u24 v3, 120, v98
    v_lshl_add_u32 v3, v99, 4, v3
    v_and_b32 v4, 4, v0
    v_sub_u32 v3, v3, v4
    s_mul_i32 s8, s3, 1920
    v_add_u32 v3, s8, v3
    v_add_u32 v5, 960, v3
    v_bfe_u32 v108, v0, 2, 2
    v_lshrrev_b32 v109, 4, v0
    v_lshl_add_u32 v108, v109, 3, v108
    v_mul_u32_u24 v108, 120, v108
    v_and_b32 v110, 3, v0
    v_lshl_add_u32 v108, v110, 3, v108
    s_lshl_b32 s13, s3, 5
    v_add_u32 v108, s13, v108
    s_mul_i32 s13, s3, 2304
    v_and_b32 v110, 15, v0
    v_mul_u32_u24 v110, 144, v110
    v_lshl_add_u32 v110, v109, 4, v110
    v_add_u32 v110, s13, v110
    v_mul_u32_u24 v111, 144, v98
    v_lshl_add_u32 v111, v99, 4, v111
    v_add_u32 v111, s13, v111
    v_mul_u32_u24 v109, 2304, v98
    v_lshl_add_u32 v109, v99, 4, v109
    s_mul_i32 s6, s65, 60
    s_lshl_b32 s7, s3, 4
    s_add_u32 s6, s6, s7
    s_mul_i32 s6, s6, 2304
    s_lshl_b32 s7, s64, 7
    s_add_u32 s6, s6, s7
    s_add_u32 s13, s6, 18432
    s_waitcnt vmcnt(0)
    s_mov_b32 s14, 200000
L_poll10:
    buffer_load_dwordx4 v[24:27], v2, s[56:59], s66 offen sc1
    buffer_load_dwordx4 v[28:31], v2, s[56:59], s5 offen sc1
    s_sub_u32 s14, s14, 1
    s_waitcnt vmcnt(0)
    v_xor_b32 v4, s15, v27
    v_bitop3_b32 v4, v31, v4, s15 bitop3:0xde
    s_mov_b32 exec_lo, 0x88888888
    s_mov_b32 exec_hi, 0x88888888
    v_cmp_ne_u32 vcc, 0, v4
    s_mov_b64 exec, -1
    s_cbranch_vccz L_pok10
    s_sleep 2
    s_cmp_lg_u32 s14, 0
    s_cbranch_scc1 L_poll10
L_pok10:
    ds_write2_b32 v3, v24, v25 offset0:0 offset1:1
    ds_write_b32 v3, v26 offset:8
    ds_write2_b32 v5, v28, v29 offset0:0 offset1:1
    ds_write_b32 v5, v30 offset:8
    s_mov_b32 exec_lo, 0x77777777
    s_mov_b32 exec_hi, 0x77777777
    ds_write_b32 v3, v27 offset:12
    ds_write_b32 v5, v31 offset:12
    s_mov_b64 exec, -1
    s_waitcnt lgkmcnt(0)
    s_barrier
    ds_read_b64_tr_b16 v[112:113], v108 offset:0
    ds_read_b64_tr_b16 v[114:115], v108 offset:480
    ds_read_b64_tr_b16 v[116:117], v108 offset:3840
    ds_read_b64_tr_b16 v[118:119], v108 offset:4320
    s_waitcnt lgkmcnt(2)
    ds_write_b128 v110, v[112:115] offset:8192
    s_waitcnt lgkmcnt(1)
    ds_write_b128 v110, v[116:119] offset:8256
    ds_read_b128 v[120:123], v111 offset:8192
    ds_read_b128 v[124:127], v111 offset:9344
    s_waitcnt lgkmcnt(1)
    buffer_store_dwordx4 v[120:123], v109, s[72:75], s6 offen sc1
    s_cmp_eq_u32 s3, 3
    s_cselect_b32 exec_hi, 0, -1
    s_waitcnt lgkmcnt(0)
    buffer_store_dwordx4 v[124:127], v109, s[72:75], s13 offen sc1
L_a_end:
    s_endpgm
L_code_end:
.section .rodata,"a"
.p2align 6
.amdhsa_kernel concat_heads__ssm_conv_s4__spectral_gfnet__prompt_kernel
  .amdhsa_next_free_vgpr 128
  .amdhsa_next_free_sgpr 80
  .amdhsa_accum_offset 128
  .amdhsa_group_segment_fixed_size 0
  .amdhsa_kernarg_size 120
  .amdhsa_user_sgpr_count 2
  .amdhsa_user_sgpr_kernarg_segment_ptr 1
  .amdhsa_system_sgpr_workgroup_id_x 1
.end_amdhsa_kernel
```
